```python
import torch

def _softmax(x, axis=-1):
    return torch.softmax(x, dim=axis)
def _gelu(x):
    return torch.nn.functional.gelu(x, approximate="tanh")
def _silu(x):
    return torch.nn.functional.silu(x)
def _sigmoid(x):
    return torch.sigmoid(x)
def _layernorm(x, axis=-1, eps=1e-5):
    m = x.mean(dim=axis, keepdim=True)
    v = x.var(dim=axis, keepdim=True, unbiased=False)
    return (x - m) / torch.sqrt(v + eps)
def _scatter_add(tgt, idx, src, axis=0):
    return tgt.clone().index_add_(axis, idx, src)
def _segment_sum(src, seg, n):
    out = torch.zeros((n,) + src.shape[1:], dtype=src.dtype)
    return out.index_add_(0, seg, src)
def _pad(x, pw):
    flat = tuple(v for pair in reversed(pw) for v in pair)
    return torch.nn.functional.pad(x, flat)

kernel_name = 'concat_heads__sliding_block__linear_attn_block__prompt'

def setup_inputs():

    _w = (lambda a: (lambda t: t.to(torch.bfloat16) if t.is_floating_point() else t)(torch.as_tensor(a)))
    def _A_setup():
        B, S, D = 1, 2048, 640
        return {
            "x": _w((lambda *s: torch.randn(*s, dtype=torch.bfloat16) * 0.2)(B, S, D)),
            "wqkv": _w((lambda *s: torch.randn(*s, dtype=torch.bfloat16) * 0.2)(D, 3 * D)),
            "wo": _w((lambda *s: torch.randn(*s, dtype=torch.bfloat16) * 0.05)(D, D)),
        }
    _A_in = _A_setup()

    def _B_setup():
        B, S, D = 1, 2048, 640
        return {
            "x": _w((lambda *s: torch.randn(*s, dtype=torch.bfloat16) * 0.05)(B, S, D)),
            "wqkv": _w((lambda *s: torch.randn(*s, dtype=torch.bfloat16) * 1.6)(D, 3 * D)),
            "wo": _w((lambda *s: torch.randn(*s, dtype=torch.bfloat16) * 0.8)(D, D)),
        }
    _B_in = _B_setup()

    return {
        "A_x": _A_in["x"],
        "A_wqkv": _A_in["wqkv"],
        "A_wo": _A_in["wo"],
        "B_x": _B_in["x"],
        "B_wqkv": _B_in["wqkv"],
        "B_wo": _B_in["wo"],
    }

def reference(A_x, A_wqkv, A_wo, B_x, B_wqkv, B_wo):
    def _A_ref(x, wqkv, wo):
        B, S, D = x.shape
        H = 32; Dh = D // H; W = 256
        qkv = (lambda x, *d: x.permute(*d))((x @ wqkv).reshape(B, S, 3, H, Dh), 2, 0, 3, 1, 4)
        q, k, v = qkv[0], qkv[1], qkv[2]
        scores = torch.einsum("bhqd,bhkd->bhqk", q, k) * (Dh ** -0.5)
        idx = torch.arange(S)
        mask = (idx[:, None] - idx[None, :] >= 0) & (idx[:, None] - idx[None, :] < W)
        scores = torch.where(mask[None, None], scores, -1e9)
        p = _softmax(scores, axis=-1)
        o = torch.einsum("bhqk,bhkd->bhqd", p, v)
        return (lambda x, *d: x.permute(*d))(o, 0, 2, 1, 3).reshape(B, S, D) @ wo

    def _B_ref(x, wqkv, wo):
        B, S, D = x.shape
        H = 32; Dh = D // H
        qkv = (lambda x, *d: x.permute(*d))((x @ wqkv).reshape(B, S, 3, H, Dh), 2, 0, 3, 1, 4)
        q, k, v = qkv[0], qkv[1], qkv[2]
        phi = lambda t: torch.where(t > 0, t + 1, torch.exp(t)) + 1e-6
        pq, pk = phi(q), phi(k)
        kv = torch.einsum("bhsd,bhse->bhde", pk, v)
        z = torch.einsum("bhsd->bhd", pk)
        num = torch.einsum("bhqd,bhde->bhqe", pq, kv)
        den = torch.einsum("bhqd,bhd->bhq", pq, z)[..., None] + 1e-6
        o = num / den
        return (lambda x, *d: x.permute(*d))(o, 0, 2, 1, 3).reshape(B, S, D) @ wo

    a = _A_ref(A_x, A_wqkv, A_wo)
    b = _B_ref(B_x, B_wqkv, B_wo)
    return torch.concatenate([a, b], axis=-1)
```

```asm
; @launch grid=(256,1,1) block=(512,1,1) lds=163840
.amdgcn_target "amdgcn-amd-amdhsa--gfx950"
.text
.globl concat_heads__sliding_block__linear_attn_block__prompt_kernel
.p2align 8
.type concat_heads__sliding_block__linear_attn_block__prompt_kernel,@function
concat_heads__sliding_block__linear_attn_block__prompt_kernel:
    s_cmp_ge_u32 s2, 256
    s_cbranch_scc1 L_end
    s_load_dwordx16 s[4:19], s[0:1], 0
    s_load_dwordx2 s[20:21], s[0:1], 64
    s_and_b32 s54, s2, 7
    s_lshr_b32 s22, s2, 3
    v_lshrrev_b32 v4, 6, v0
    v_and_b32 v1, 63, v0
    v_and_b32 v2, 15, v0
    v_readfirstlane_b32 s51, v4
    v_lshrrev_b32 v3, 4, v1
    s_and_b32 s48, s54, 1
    s_lshr_b32 s56, s54, 1
    s_and_b32 s57, s56, 1
    s_lshl_b32 s57, s57, 3
    s_and_b32 s58, s22, 7
    s_add_u32 s49, s57, s58
    s_lshr_b32 s57, s56, 1
    s_lshr_b32 s58, s22, 3
    s_lshl_b32 s59, s57, 2
    s_add_u32 s50, s59, s58
    s_lshl_b32 s57, s57, 1
    s_and_b32 s59, s58, 1
    s_add_u32 s57, s57, s59
    s_lshr_b32 s58, s58, 1
    s_lshl_b32 s58, s58, 2
    s_add_u32 s82, s57, s58
    s_and_b32 s52, s51, 3
    s_lshr_b32 s53, s51, 2
    s_cmp_eq_u32 s51, 7
    s_cbranch_scc0 L_ow_1
    s_getpc_b64 s[56:57]
L_pcbase:
    s_and_b32 s58, s22, 7
    s_mul_i32 s58, s58, CODE_CHUNK
    v_lshlrev_b32 v4, 7, v1
    v_add_u32 v4, s58, v4
    v_min_u32 v4, CODE_LAST, v4
    global_load_dword v245, v4, s[56:57]
L_ow_1:
    s_cmp_eq_u32 s53, 0
    s_cbranch_scc0 L_rx_2
    s_mul_i32 s54, s52, 61440
    s_mul_i32 s55, s50, 160
    s_mul_i32 s56, s82, 320
    s_cmp_eq_u32 s48, 0
    s_cselect_b32 s56, s56, s55
    s_cselect_b32 s59, 0, 1120
    s_add_u32 s56, s56, s54
    s_add_u32 s56, s56, 1280
    s_add_u32 s54, s54, s55
    s_sub_u32 s93, s54, s56
    s_sub_u32 s94, 245600, s59
    s_movk_i32 s55, 3277
    s_movk_i32 s57, 3840
    v_add_u32 v4, 0, v1
    v_mul_u32_u24 v5, s55, v4
    v_lshrrev_b32 v5, 16, v5
    v_mul_u32_u24 v6, 20, v5
    v_lshrrev_b32 v7, 2, v5
    v_sub_u32 v6, v4, v6
    v_and_b32 v7, 2, v7
    v_sub_u32 v7, v6, v7
    v_add_u32 v8, 20, v7
    v_min_u32 v7, v7, v8
    v_add_u32 v240, 6, v7
    v_lshrrev_b32 v240, 4, v240
    v_mul_u32_u24 v5, s57, v5
    v_lshl_add_u32 v5, v7, 4, v5
    v_mad_u32_u24 v6, v240, s59, v5
    v_add_u32 v10, s56, v6
    v_add_u32 v4, 64, v1
    v_mul_u32_u24 v5, s55, v4
    v_lshrrev_b32 v5, 16, v5
    v_mul_u32_u24 v6, 20, v5
    v_lshrrev_b32 v7, 2, v5
    v_sub_u32 v6, v4, v6
    v_and_b32 v7, 2, v7
    v_sub_u32 v7, v6, v7
    v_add_u32 v8, 20, v7
    v_min_u32 v7, v7, v8
    v_add_u32 v241, 6, v7
    v_lshrrev_b32 v241, 4, v241
    v_mul_u32_u24 v5, s57, v5
    v_lshl_add_u32 v5, v7, 4, v5
    v_mad_u32_u24 v6, v241, s59, v5
    v_add_u32 v11, s56, v6
    v_add_u32 v4, 128, v1
    v_mul_u32_u24 v5, s55, v4
    v_lshrrev_b32 v5, 16, v5
    v_mul_u32_u24 v6, 20, v5
    v_lshrrev_b32 v7, 2, v5
    v_sub_u32 v6, v4, v6
    v_and_b32 v7, 2, v7
    v_sub_u32 v7, v6, v7
    v_add_u32 v8, 20, v7
    v_min_u32 v7, v7, v8
    v_add_u32 v242, 6, v7
    v_lshrrev_b32 v242, 4, v242
    v_mul_u32_u24 v5, s57, v5
    v_lshl_add_u32 v5, v7, 4, v5
    v_mad_u32_u24 v6, v242, s59, v5
    v_add_u32 v12, s56, v6
    v_add_u32 v4, 192, v1
    v_mul_u32_u24 v5, s55, v4
    v_lshrrev_b32 v5, 16, v5
    v_mul_u32_u24 v6, 20, v5
    v_lshrrev_b32 v7, 2, v5
    v_sub_u32 v6, v4, v6
    v_and_b32 v7, 2, v7
    v_sub_u32 v7, v6, v7
    v_add_u32 v8, 20, v7
    v_min_u32 v7, v7, v8
    v_add_u32 v243, 6, v7
    v_lshrrev_b32 v243, 4, v243
    v_mul_u32_u24 v5, s57, v5
    v_lshl_add_u32 v5, v7, 4, v5
    v_mad_u32_u24 v6, v243, s59, v5
    v_add_u32 v13, s56, v6
    v_add_u32 v4, 256, v1
    v_mul_u32_u24 v5, s55, v4
    v_lshrrev_b32 v5, 16, v5
    v_mul_u32_u24 v6, 20, v5
    v_lshrrev_b32 v7, 2, v5
    v_sub_u32 v6, v4, v6
    v_and_b32 v7, 2, v7
    v_sub_u32 v7, v6, v7
    v_add_u32 v8, 20, v7
    v_min_u32 v7, v7, v8
    v_add_u32 v244, 6, v7
    v_lshrrev_b32 v244, 4, v244
    v_mul_u32_u24 v5, s57, v5
    v_lshl_add_u32 v5, v7, 4, v5
    v_mad_u32_u24 v6, v244, s59, v5
    v_add_u32 v14, s56, v6
    s_mul_i32 s54, s52, 5120
    s_add_u32 s72, s54, 65536
    s_add_u32 s73, s54, 86016
    s_add_u32 s74, s54, 106496
    s_add_u32 s75, s54, 126976
    s_mov_b32 s77, 245760
    s_mov_b32 s79, 0
    s_mov_b32 s80, 0
    s_mov_b32 s81, 0
    s_branch L_rd_3
L_rx_2:
    s_lshl_b32 s54, s49, 7
    s_lshl_b32 s55, s52, 5
    s_add_u32 s54, s54, s55
    s_mul_i32 s54, s54, 1280
    s_movk_i32 s55, 1280
    v_lshrrev_b32 v4, 3, v1
    v_and_b32 v5, 7, v1
    v_xor_b32 v5, v5, v4
    v_mul_u32_u24 v4, s55, v4
    v_lshl_add_u32 v4, v5, 4, v4
    v_add_u32 v10, s54, v4
    v_mov_b32 v11, v10
    v_mov_b32 v12, v10
    v_mov_b32 v13, v10
    v_mov_b32 v14, v10
    v_mov_b32 v240, 0
    v_mov_b32 v241, 0
    v_mov_b32 v242, 0
    v_mov_b32 v243, 0
    v_mov_b32 v244, 0
    s_lshl_b32 s54, s52, 12
    s_add_u32 s72, s54, 0
    s_add_u32 s73, s54, 16384
    s_add_u32 s74, s54, 32768
    s_add_u32 s75, s54, 49152
    s_movk_i32 s77, 128
    s_mov_b32 s79, 10240
    s_mov_b32 s80, 20480
    s_mov_b32 s81, 30720
    s_mov_b32 s93, 0
    s_mov_b32 s94, 0
L_rd_3:
    s_mov_b32 s76, 0
    s_waitcnt lgkmcnt(0)
    s_cmp_eq_u32 s48, 0
    s_cselect_b32 s24, s4, s10
    s_cselect_b32 s25, s5, s11
    s_mov_b32 s26, 2621440
    s_mov_b32 s27, 0x20000
    s_cselect_b32 s28, s6, s12
    s_cselect_b32 s29, s7, s13
    s_mov_b32 s30, 2457600
    s_mov_b32 s31, 0x20000
    s_cmp_eq_u32 s53, 0
    s_cselect_b32 s68, s28, s24
    s_cselect_b32 s69, s29, s25
    s_cselect_b32 s70, s30, s26
    s_mov_b32 s71, 0x20000
    s_add_u32 m0, s72, 0
    s_nop 0
    buffer_load_dwordx4 v10, s[68:71], s76 offen  lds
    s_add_u32 m0, s72, 1024
    s_add_u32 s61, s76, s79
    buffer_load_dwordx4 v11, s[68:71], s61 offen  lds
    s_add_u32 m0, s72, 2048
    s_add_u32 s61, s76, s80
    buffer_load_dwordx4 v12, s[68:71], s61 offen  lds
    s_add_u32 m0, s72, 3072
    s_add_u32 s61, s76, s81
    buffer_load_dwordx4 v13, s[68:71], s61 offen  lds
    s_cmp_eq_u32 s53, 0
    s_cbranch_scc0 L_rd_5
    s_add_u32 m0, s72, 4096
    s_nop 0
    buffer_load_dwordx4 v14, s[68:71], s76 offen  lds
L_rd_5:
    s_add_u32 s76, s76, s77
    s_cmp_eq_u32 s53, 0
    s_cbranch_scc0 L_rx_6
    v_mad_u32_u24 v240, v240, s94, v10
    v_add_u32 v240, s93, v240
    v_mad_u32_u24 v241, v241, s94, v11
    v_add_u32 v241, s93, v241
    v_mad_u32_u24 v242, v242, s94, v12
    v_add_u32 v242, s93, v242
    v_mad_u32_u24 v243, v243, s94, v13
    v_add_u32 v243, s93, v243
    v_mad_u32_u24 v244, v244, s94, v14
    v_add_u32 v244, s93, v244
    s_movk_i32 s57, 3840
    v_and_b32 v4, 31, v1
    v_lshrrev_b32 v5, 5, v1
    v_min_u32 v4, 19, v4
    s_lshr_b32 s54, s50, 2
    v_mul_u32_u24 v6, 13, v4
    v_lshrrev_b32 v6, 7, v6
    v_mul_u32_u24 v7, 52, v4
    v_lshrrev_b32 v7, 8, v7
    v_mul_u32_u24 v8, 5, v7
    v_sub_u32 v8, v4, v8
    v_lshlrev_b32 v8, 7, v8
    v_lshl_add_u32 v6, v5, 6, v6
    s_lshl_b32 s56, s22, 1
    v_add_u32 v6, s56, v6
    v_mul_u32_u24 v6, s57, v6
    v_and_b32 v9, 1, v7
    s_movk_i32 s56, 1280
    v_mul_u32_u24 v9, s56, v9
    v_add3_u32 v6, v6, v9, v8
    s_mul_i32 s54, s54, 640
    s_add_u32 s56, s54, 1280
    v_add_u32 v30, s56, v6
    v_lshl_add_u32 v7, v5, 7, v7
    s_lshl_b32 s56, s22, 2
    v_add_u32 v7, s56, v7
    v_mul_u32_u24 v7, s57, v7
    v_add3_u32 v31, v7, v8, s54
    v_mov_b32 v29, 0
    s_branch L_rd_7
L_rx_6:
    s_movk_i32 s55, 1280
    v_and_b32 v4, 31, v1
    v_lshrrev_b32 v5, 5, v1
    s_lshr_b32 s54, s49, 3
    s_lshl_b32 s54, s54, 5
    s_add_u32 s54, s54, s22
    s_mul_i32 s54, s54, 40960
    v_mul_u32_u24 v6, s55, v4
    v_lshl_add_u32 v6, v5, 7, v6
    v_add_u32 v29, s54, v6
    v_mov_b32 v30, 0
    v_mov_b32 v31, 0
L_rd_7:
    s_cmp_eq_u32 s51, 4
    s_cbranch_scc0 L_ow_8
    s_mov_b32 s61, 0
    buffer_load_dword v245, v29, s[24:27], s61 offen
L_ow_8:
    s_cmp_eq_u32 s51, 0
    s_cbranch_scc0 L_ow_9
    s_mov_b32 s61, 0
    buffer_load_dword v245, v30, s[28:31], s61 offen
L_ow_9:
    s_cmp_eq_u32 s51, 5
    s_cbranch_scc0 L_ow_10
    s_mov_b32 s61, 256
    buffer_load_dword v245, v29, s[24:27], s61 offen
L_ow_10:
    s_cmp_eq_u32 s51, 1
    s_cbranch_scc0 L_ow_11
    s_mov_b32 s61, 491520
    buffer_load_dword v245, v30, s[28:31], s61 offen
L_ow_11:
    s_mov_b32 s32, s20
    s_mov_b32 s33, s21
    s_mov_b32 s34, 17825792
    s_mov_b32 s35, 0x20000
    s_mov_b32 s36, s16
    s_mov_b32 s37, s17
    s_mov_b32 s38, 5242880
    s_mov_b32 s39, 0x20000
    s_mov_b32 s40, s8
    s_mov_b32 s41, s9
    s_mov_b32 s42, 819200
    s_mov_b32 s43, 0x20000
    s_mov_b32 s44, s14
    s_mov_b32 s45, s15
    s_mov_b32 s46, 819200
    s_mov_b32 s47, 0x20000
    v_and_b32 v4, 7, v2
    s_lshl_b32 s54, s52, 12
    v_lshlrev_b32 v5, 7, v2
    v_xor_b32 v4, v4, v3
    v_lshl_add_u32 v4, v4, 4, v5
    s_xor_b32 s59, s53, 1
    s_lshl_b32 s55, s59, 6
    s_lshl_b32 s56, s53, 11
    s_or_b32 s55, s55, s56
    s_or_b32 s55, s55, s54
    v_xor_b32 v15, s55, v4
    v_xor_b32 v16, 0x800, v15
    v_xor_b32 v17, 64, v15
    v_xor_b32 v18, 64, v16
    v_and_b32 v4, 3, v2
    v_lshrrev_b32 v121, 2, v2
    v_and_b32 v7, 1, v3
    v_lshl_add_u32 v121, v3, 3, v121
    s_movk_i32 s55, 320
    v_lshlrev_b32 v7, 5, v7
    v_mul_u32_u24 v121, s55, v121
    v_lshl_add_u32 v120, v4, 3, v7
    v_add_u32 v121, 65536, v121
    v_add_u32 v122, v121, v120
    s_mul_i32 s56, s53, 160
    s_mul_i32 s57, s53, 80
    s_mul_i32 s54, s59, 10240
    s_mul_i32 s55, s53, 10240
    s_add_u32 s58, s56, 0
    s_add_u32 s59, s57, 0
    s_cmp_eq_u32 s48, 0
    s_cselect_b32 s58, s58, s59
    s_add_u32 s59, s58, s54
    v_add_u32 v19, s59, v122
    s_add_u32 s59, s58, s55
    v_add_u32 v24, s59, v122
    s_add_u32 s58, s56, 40
    s_add_u32 s59, s57, 40
    s_cmp_eq_u32 s48, 0
    s_cselect_b32 s58, s58, s59
    s_add_u32 s59, s58, s54
    v_add_u32 v20, s59, v122
    s_add_u32 s59, s58, s55
    v_add_u32 v25, s59, v122
    s_add_u32 s58, s56, 80
    s_add_u32 s59, s57, 160
    s_cmp_eq_u32 s48, 0
    s_cselect_b32 s58, s58, s59
    s_add_u32 s59, s58, s54
    v_add_u32 v21, s59, v122
    s_add_u32 s59, s58, s55
    v_add_u32 v26, s59, v122
    s_add_u32 s58, s56, 120
    s_add_u32 s59, s57, 200
    s_cmp_eq_u32 s48, 0
    s_cselect_b32 s58, s58, s59
    v_add_u32 v5, s58, v120
    v_subrev_u32 v124, 320, v5
    v_min_u32 v5, v5, v124
    v_add_u32 v5, v5, v121
    v_add_u32 v22, s54, v5
    v_add_u32 v27, s55, v5
    s_cmp_eq_u32 s48, 0
    s_cselect_b32 s58, s56, s57
    s_cselect_b32 s59, 0, 80
    s_add_u32 s58, s58, 32
    v_mul_u32_u24 v123, 40, v4
    v_lshrrev_b32 v5, 1, v4
    v_add_u32 v123, v123, v7
    v_mad_u32_u24 v5, v5, s59, v123
    v_add_u32 v5, s58, v5
    v_subrev_u32 v124, 320, v5
    v_min_u32 v5, v5, v124
    v_add_u32 v5, v5, v121
    v_add_u32 v23, s54, v5
    v_add_u32 v28, s55, v5
    s_add_u32 m0, s73, 0
    s_nop 0
    buffer_load_dwordx4 v10, s[68:71], s76 offen  lds
    s_add_u32 m0, s73, 1024
    s_add_u32 s61, s76, s79
    buffer_load_dwordx4 v11, s[68:71], s61 offen  lds
    s_add_u32 m0, s73, 2048
    s_add_u32 s61, s76, s80
    buffer_load_dwordx4 v12, s[68:71], s61 offen  lds
    s_add_u32 m0, s73, 3072
    s_add_u32 s61, s76, s81
    buffer_load_dwordx4 v13, s[68:71], s61 offen  lds
    s_cmp_eq_u32 s53, 0
    s_cbranch_scc0 L_rd_13
    s_add_u32 m0, s73, 4096
    s_nop 0
    buffer_load_dwordx4 v14, s[68:71], s76 offen  lds
L_rd_13:
    s_add_u32 s76, s76, s77
    s_cmp_eq_u32 s51, 6
    s_cbranch_scc0 L_ow_14
    s_mov_b32 s61, 512
    buffer_load_dword v245, v29, s[24:27], s61 offen
L_ow_14:
    s_cmp_eq_u32 s51, 2
    s_cbranch_scc0 L_ow_15
    s_mov_b32 s61, 983040
    buffer_load_dword v245, v30, s[28:31], s61 offen
L_ow_15:
    v_mov_b32 v8, 0
    s_mov_b32 s61, 16777216
    buffer_load_dword v9, v8, s[32:35], s61 offen sc1
    s_cmp_eq_u32 s53, 0
    s_cbranch_scc0 L_rx_16
    s_waitcnt vmcnt(6)
    s_branch L_rd_17
L_rx_16:
    s_waitcnt vmcnt(5)
L_rd_17:
    s_barrier
    ds_read_b128 v[32:35], v15 offset:0
    ds_read_b128 v[36:39], v16 offset:0
    ds_read_b64_tr_b16 v[40:41], v19 offset:0
    ds_read_b64_tr_b16 v[42:43], v19 offset:1280
    ds_read_b64_tr_b16 v[44:45], v20 offset:0
    ds_read_b64_tr_b16 v[46:47], v20 offset:1280
    ds_read_b64_tr_b16 v[48:49], v21 offset:0
    ds_read_b64_tr_b16 v[50:51], v21 offset:1280
    ds_read_b64_tr_b16 v[52:53], v22 offset:0
    ds_read_b64_tr_b16 v[54:55], v22 offset:1280
    ds_read_b64_tr_b16 v[56:57], v23 offset:0
    ds_read_b64_tr_b16 v[58:59], v23 offset:1280
    s_waitcnt lgkmcnt(8)
    v_mfma_f32_16x16x32_bf16 v[80:83], v[32:35], v[40:43], 0
    ds_read_b128 v[160:163], v17 offset:0
    ds_read_b128 v[164:167], v18 offset:0
    s_add_u32 m0, s74, 0
    s_nop 0
    buffer_load_dwordx4 v10, s[68:71], s76 offen  lds
    v_mfma_f32_16x16x32_bf16 v[100:103], v[36:39], v[40:43], 0
    ds_read_b64_tr_b16 v[60:61], v24 offset:0
    s_waitcnt lgkmcnt(9)
    v_mfma_f32_16x16x32_bf16 v[84:87], v[32:35], v[44:47], 0
    ds_read_b64_tr_b16 v[62:63], v24 offset:1280
    s_add_u32 m0, s74, 1024
    s_add_u32 s61, s76, s79
    buffer_load_dwordx4 v11, s[68:71], s61 offen  lds
    v_mfma_f32_16x16x32_bf16 v[104:107], v[36:39], v[44:47], 0
    ds_read_b64_tr_b16 v[64:65], v25 offset:0
    s_waitcnt lgkmcnt(9)
    v_mfma_f32_16x16x32_bf16 v[88:91], v[32:35], v[48:51], 0
    ds_read_b64_tr_b16 v[66:67], v25 offset:1280
    s_add_u32 m0, s74, 2048
    s_add_u32 s61, s76, s80
    buffer_load_dwordx4 v12, s[68:71], s61 offen  lds
    v_mfma_f32_16x16x32_bf16 v[108:111], v[36:39], v[48:51], 0
    ds_read_b64_tr_b16 v[68:69], v26 offset:0
    ds_read_b64_tr_b16 v[70:71], v26 offset:1280
    s_waitcnt lgkmcnt(10)
    v_mfma_f32_16x16x32_bf16 v[92:95], v[32:35], v[52:55], 0
    ds_read_b64_tr_b16 v[72:73], v27 offset:0
    s_add_u32 m0, s74, 3072
    s_add_u32 s61, s76, s81
    buffer_load_dwordx4 v13, s[68:71], s61 offen  lds
    v_mfma_f32_16x16x32_bf16 v[112:115], v[36:39], v[52:55], 0
    ds_read_b64_tr_b16 v[74:75], v27 offset:1280
    s_waitcnt lgkmcnt(10)
    v_mfma_f32_16x16x32_bf16 v[96:99], v[32:35], v[56:59], 0
    ds_read_b64_tr_b16 v[76:77], v28 offset:0
    s_cmp_eq_u32 s53, 0
    s_cbranch_scc0 L_rd_19
    s_add_u32 m0, s74, 4096
    s_nop 0
    buffer_load_dwordx4 v14, s[68:71], s76 offen  lds
L_rd_19:
    s_add_u32 s76, s76, s77
    v_mfma_f32_16x16x32_bf16 v[116:119], v[36:39], v[56:59], 0
    ds_read_b64_tr_b16 v[78:79], v28 offset:1280
    s_cmp_eq_u32 s53, 0
    s_cbranch_scc0 L_rx_20
    s_waitcnt vmcnt(6)
    s_branch L_rd_21
L_rx_20:
    s_waitcnt vmcnt(5)
L_rd_21:
    s_barrier
    s_waitcnt lgkmcnt(8)
    v_mfma_f32_16x16x32_bf16 v[80:83], v[160:163], v[60:63], v[80:83]
    ds_read_b128 v[32:35], v15 offset:16384
    ds_read_b128 v[36:39], v16 offset:16384
    v_mfma_f32_16x16x32_bf16 v[100:103], v[164:167], v[60:63], v[100:103]
    ds_read_b64_tr_b16 v[40:41], v19 offset:20480
    s_add_u32 m0, s75, 0
    s_nop 0
    buffer_load_dwordx4 v10, s[68:71], s76 offen  lds
    s_waitcnt lgkmcnt(9)
    v_mfma_f32_16x16x32_bf16 v[84:87], v[160:163], v[64:67], v[84:87]
    ds_read_b64_tr_b16 v[42:43], v19 offset:21760
    v_mfma_f32_16x16x32_bf16 v[104:107], v[164:167], v[64:67], v[104:107]
    ds_read_b64_tr_b16 v[44:45], v20 offset:20480
    s_waitcnt lgkmcnt(9)
    v_mfma_f32_16x16x32_bf16 v[88:91], v[160:163], v[68:71], v[88:91]
    ds_read_b64_tr_b16 v[46:47], v20 offset:21760
    s_add_u32 m0, s75, 1024
    s_add_u32 s61, s76, s79
    buffer_load_dwordx4 v11, s[68:71], s61 offen  lds
    v_mfma_f32_16x16x32_bf16 v[108:111], v[164:167], v[68:71], v[108:111]
    ds_read_b64_tr_b16 v[48:49], v21 offset:20480
    ds_read_b64_tr_b16 v[50:51], v21 offset:21760
    s_waitcnt lgkmcnt(10)
    v_mfma_f32_16x16x32_bf16 v[92:95], v[160:163], v[72:75], v[92:95]
    ds_read_b64_tr_b16 v[52:53], v22 offset:20480
    v_mfma_f32_16x16x32_bf16 v[112:115], v[164:167], v[72:75], v[112:115]
    ds_read_b64_tr_b16 v[54:55], v22 offset:21760
    s_add_u32 m0, s75, 2048
    s_add_u32 s61, s76, s80
    buffer_load_dwordx4 v12, s[68:71], s61 offen  lds
    s_waitcnt lgkmcnt(10)
    v_mfma_f32_16x16x32_bf16 v[96:99], v[160:163], v[76:79], v[96:99]
    ds_read_b64_tr_b16 v[56:57], v23 offset:20480
    v_mfma_f32_16x16x32_bf16 v[116:119], v[164:167], v[76:79], v[116:119]
    ds_read_b64_tr_b16 v[58:59], v23 offset:21760
    s_cmp_eq_u32 s51, 7
    s_cbranch_scc0 L_ow_22
    s_mov_b32 s61, 768
    buffer_load_dword v245, v29, s[24:27], s61 offen
L_ow_22:
    s_cmp_eq_u32 s51, 3
    s_cbranch_scc0 L_ow_23
    s_mov_b32 s61, 1474560
    buffer_load_dword v245, v30, s[28:31], s61 offen
L_ow_23:
    s_waitcnt lgkmcnt(8)
    v_mfma_f32_16x16x32_bf16 v[80:83], v[32:35], v[40:43], v[80:83]
    ds_read_b128 v[168:171], v17 offset:16384
    ds_read_b128 v[172:175], v18 offset:16384
    v_mfma_f32_16x16x32_bf16 v[100:103], v[36:39], v[40:43], v[100:103]
    ds_read_b64_tr_b16 v[60:61], v24 offset:20480
    s_waitcnt lgkmcnt(9)
    v_mfma_f32_16x16x32_bf16 v[84:87], v[32:35], v[44:47], v[84:87]
    ds_read_b64_tr_b16 v[62:63], v24 offset:21760
    s_add_u32 m0, s75, 3072
    s_add_u32 s61, s76, s81
    buffer_load_dwordx4 v13, s[68:71], s61 offen  lds
    v_mfma_f32_16x16x32_bf16 v[104:107], v[36:39], v[44:47], v[104:107]
    ds_read_b64_tr_b16 v[64:65], v25 offset:20480
    s_waitcnt lgkmcnt(9)
    v_mfma_f32_16x16x32_bf16 v[88:91], v[32:35], v[48:51], v[88:91]
    ds_read_b64_tr_b16 v[66:67], v25 offset:21760
    v_mfma_f32_16x16x32_bf16 v[108:111], v[36:39], v[48:51], v[108:111]
    ds_read_b64_tr_b16 v[68:69], v26 offset:20480
    ds_read_b64_tr_b16 v[70:71], v26 offset:21760
    s_waitcnt lgkmcnt(10)
    v_mfma_f32_16x16x32_bf16 v[92:95], v[32:35], v[52:55], v[92:95]
    ds_read_b64_tr_b16 v[72:73], v27 offset:20480
    s_cmp_eq_u32 s53, 0
    s_cbranch_scc0 L_rd_25
    s_add_u32 m0, s75, 4096
    s_nop 0
    buffer_load_dwordx4 v14, s[68:71], s76 offen  lds
L_rd_25:
    s_add_u32 s76, s76, s77
    v_mfma_f32_16x16x32_bf16 v[112:115], v[36:39], v[52:55], v[112:115]
    ds_read_b64_tr_b16 v[74:75], v27 offset:21760
    s_waitcnt lgkmcnt(10)
    v_mfma_f32_16x16x32_bf16 v[96:99], v[32:35], v[56:59], v[96:99]
    ds_read_b64_tr_b16 v[76:77], v28 offset:20480
    v_mfma_f32_16x16x32_bf16 v[116:119], v[36:39], v[56:59], v[116:119]
    ds_read_b64_tr_b16 v[78:79], v28 offset:21760
    s_cmp_eq_u32 s53, 0
    s_cbranch_scc0 L_rx_26
    s_waitcnt vmcnt(5)
    s_branch L_rd_27
L_rx_26:
    s_waitcnt vmcnt(4)
L_rd_27:
    s_barrier
    s_waitcnt lgkmcnt(8)
    v_mfma_f32_16x16x32_bf16 v[80:83], v[168:171], v[60:63], v[80:83]
    ds_read_b128 v[32:35], v15 offset:32768
    ds_read_b128 v[36:39], v16 offset:32768
    v_mfma_f32_16x16x32_bf16 v[100:103], v[172:175], v[60:63], v[100:103]
    ds_read_b64_tr_b16 v[40:41], v19 offset:40960
    s_add_u32 m0, s72, 0
    s_nop 0
    buffer_load_dwordx4 v10, s[68:71], s76 offen  lds
    s_waitcnt lgkmcnt(9)
    v_mfma_f32_16x16x32_bf16 v[84:87], v[168:171], v[64:67], v[84:87]
    ds_read_b64_tr_b16 v[42:43], v19 offset:42240
    v_mfma_f32_16x16x32_bf16 v[104:107], v[172:175], v[64:67], v[104:107]
    ds_read_b64_tr_b16 v[44:45], v20 offset:40960
    s_waitcnt lgkmcnt(9)
    v_mfma_f32_16x16x32_bf16 v[88:91], v[168:171], v[68:71], v[88:91]
    ds_read_b64_tr_b16 v[46:47], v20 offset:42240
    s_add_u32 m0, s72, 1024
    s_add_u32 s61, s76, s79
    buffer_load_dwordx4 v11, s[68:71], s61 offen  lds
    v_mfma_f32_16x16x32_bf16 v[108:111], v[172:175], v[68:71], v[108:111]
    ds_read_b64_tr_b16 v[48:49], v21 offset:40960
    ds_read_b64_tr_b16 v[50:51], v21 offset:42240
    s_waitcnt lgkmcnt(10)
    v_mfma_f32_16x16x32_bf16 v[92:95], v[168:171], v[72:75], v[92:95]
    ds_read_b64_tr_b16 v[52:53], v22 offset:40960
    v_mfma_f32_16x16x32_bf16 v[112:115], v[172:175], v[72:75], v[112:115]
    ds_read_b64_tr_b16 v[54:55], v22 offset:42240
    s_add_u32 m0, s72, 2048
    s_add_u32 s61, s76, s80
    buffer_load_dwordx4 v12, s[68:71], s61 offen  lds
    s_waitcnt lgkmcnt(10)
    v_mfma_f32_16x16x32_bf16 v[96:99], v[168:171], v[76:79], v[96:99]
    ds_read_b64_tr_b16 v[56:57], v23 offset:40960
    v_mfma_f32_16x16x32_bf16 v[116:119], v[172:175], v[76:79], v[116:119]
    ds_read_b64_tr_b16 v[58:59], v23 offset:42240
    s_waitcnt lgkmcnt(8)
    v_mfma_f32_16x16x32_bf16 v[80:83], v[32:35], v[40:43], v[80:83]
    ds_read_b128 v[176:179], v17 offset:32768
    ds_read_b128 v[180:183], v18 offset:32768
    v_mfma_f32_16x16x32_bf16 v[100:103], v[36:39], v[40:43], v[100:103]
    ds_read_b64_tr_b16 v[60:61], v24 offset:40960
    s_waitcnt lgkmcnt(9)
    v_mfma_f32_16x16x32_bf16 v[84:87], v[32:35], v[44:47], v[84:87]
    ds_read_b64_tr_b16 v[62:63], v24 offset:42240
    s_add_u32 m0, s72, 3072
    s_add_u32 s61, s76, s81
    buffer_load_dwordx4 v13, s[68:71], s61 offen  lds
    v_mfma_f32_16x16x32_bf16 v[104:107], v[36:39], v[44:47], v[104:107]
    ds_read_b64_tr_b16 v[64:65], v25 offset:40960
    s_waitcnt lgkmcnt(9)
    v_mfma_f32_16x16x32_bf16 v[88:91], v[32:35], v[48:51], v[88:91]
    ds_read_b64_tr_b16 v[66:67], v25 offset:42240
    v_mfma_f32_16x16x32_bf16 v[108:111], v[36:39], v[48:51], v[108:111]
    ds_read_b64_tr_b16 v[68:69], v26 offset:40960
    ds_read_b64_tr_b16 v[70:71], v26 offset:42240
    s_waitcnt lgkmcnt(10)
    v_mfma_f32_16x16x32_bf16 v[92:95], v[32:35], v[52:55], v[92:95]
    ds_read_b64_tr_b16 v[72:73], v27 offset:40960
    s_cmp_eq_u32 s53, 0
    s_cbranch_scc0 L_rd_29
    s_add_u32 m0, s72, 4096
    s_nop 0
    buffer_load_dwordx4 v14, s[68:71], s76 offen  lds
L_rd_29:
    s_add_u32 s76, s76, s77
    v_mfma_f32_16x16x32_bf16 v[112:115], v[36:39], v[52:55], v[112:115]
    ds_read_b64_tr_b16 v[74:75], v27 offset:42240
    s_waitcnt lgkmcnt(10)
    v_mfma_f32_16x16x32_bf16 v[96:99], v[32:35], v[56:59], v[96:99]
    ds_read_b64_tr_b16 v[76:77], v28 offset:40960
    v_mfma_f32_16x16x32_bf16 v[116:119], v[36:39], v[56:59], v[116:119]
    ds_read_b64_tr_b16 v[78:79], v28 offset:42240
    s_cmp_eq_u32 s53, 0
    s_cbranch_scc0 L_rx_30
    s_waitcnt vmcnt(5)
    s_branch L_rd_31
L_rx_30:
    s_waitcnt vmcnt(4)
L_rd_31:
    s_barrier
    v_readfirstlane_b32 s3, v9
    s_nop 3
    s_add_u32 s3, s3, 0x9e3779b9
    s_waitcnt lgkmcnt(8)
    v_mfma_f32_16x16x32_bf16 v[80:83], v[176:179], v[60:63], v[80:83]
    ds_read_b128 v[32:35], v15 offset:49152
    ds_read_b128 v[36:39], v16 offset:49152
    v_mfma_f32_16x16x32_bf16 v[100:103], v[180:183], v[60:63], v[100:103]
    ds_read_b64_tr_b16 v[40:41], v19 offset:61440
    s_add_u32 m0, s73, 0
    s_nop 0
    buffer_load_dwordx4 v10, s[68:71], s76 offen  lds
    s_waitcnt lgkmcnt(9)
    v_mfma_f32_16x16x32_bf16 v[84:87], v[176:179], v[64:67], v[84:87]
    ds_read_b64_tr_b16 v[42:43], v19 offset:62720
    v_mfma_f32_16x16x32_bf16 v[104:107], v[180:183], v[64:67], v[104:107]
    ds_read_b64_tr_b16 v[44:45], v20 offset:61440
    s_waitcnt lgkmcnt(9)
    v_mfma_f32_16x16x32_bf16 v[88:91], v[176:179], v[68:71], v[88:91]
    ds_read_b64_tr_b16 v[46:47], v20 offset:62720
    s_add_u32 m0, s73, 1024
    s_add_u32 s61, s76, s79
    buffer_load_dwordx4 v11, s[68:71], s61 offen  lds
    v_mfma_f32_16x16x32_bf16 v[108:111], v[180:183], v[68:71], v[108:111]
    ds_read_b64_tr_b16 v[48:49], v21 offset:61440
    ds_read_b64_tr_b16 v[50:51], v21 offset:62720
    s_waitcnt lgkmcnt(10)
    v_mfma_f32_16x16x32_bf16 v[92:95], v[176:179], v[72:75], v[92:95]
    ds_read_b64_tr_b16 v[52:53], v22 offset:61440
    v_mfma_f32_16x16x32_bf16 v[112:115], v[180:183], v[72:75], v[112:115]
    ds_read_b64_tr_b16 v[54:55], v22 offset:62720
    s_add_u32 m0, s73, 2048
    s_add_u32 s61, s76, s80
    buffer_load_dwordx4 v12, s[68:71], s61 offen  lds
    s_waitcnt lgkmcnt(10)
    v_mfma_f32_16x16x32_bf16 v[96:99], v[176:179], v[76:79], v[96:99]
    ds_read_b64_tr_b16 v[56:57], v23 offset:61440
    v_mfma_f32_16x16x32_bf16 v[116:119], v[180:183], v[76:79], v[116:119]
    ds_read_b64_tr_b16 v[58:59], v23 offset:62720
    s_cmp_eq_u32 s51, 4
    s_cbranch_scc0 L_ow_32
    s_mov_b32 s61, 1024
    buffer_load_dword v245, v29, s[24:27], s61 offen
L_ow_32:
    s_cmp_eq_u32 s51, 0
    s_cbranch_scc0 L_ow_33
    s_mov_b32 s61, 1966080
    buffer_load_dword v245, v30, s[28:31], s61 offen
L_ow_33:
    s_waitcnt lgkmcnt(8)
    v_mfma_f32_16x16x32_bf16 v[80:83], v[32:35], v[40:43], v[80:83]
    ds_read_b128 v[184:187], v17 offset:49152
    ds_read_b128 v[188:191], v18 offset:49152
    v_mfma_f32_16x16x32_bf16 v[100:103], v[36:39], v[40:43], v[100:103]
    ds_read_b64_tr_b16 v[60:61], v24 offset:61440
    s_waitcnt lgkmcnt(9)
    v_mfma_f32_16x16x32_bf16 v[84:87], v[32:35], v[44:47], v[84:87]
    ds_read_b64_tr_b16 v[62:63], v24 offset:62720
    s_add_u32 m0, s73, 3072
    s_add_u32 s61, s76, s81
    buffer_load_dwordx4 v13, s[68:71], s61 offen  lds
    v_mfma_f32_16x16x32_bf16 v[104:107], v[36:39], v[44:47], v[104:107]
    ds_read_b64_tr_b16 v[64:65], v25 offset:61440
    s_waitcnt lgkmcnt(9)
    v_mfma_f32_16x16x32_bf16 v[88:91], v[32:35], v[48:51], v[88:91]
    ds_read_b64_tr_b16 v[66:67], v25 offset:62720
    v_mfma_f32_16x16x32_bf16 v[108:111], v[36:39], v[48:51], v[108:111]
    ds_read_b64_tr_b16 v[68:69], v26 offset:61440
    ds_read_b64_tr_b16 v[70:71], v26 offset:62720
    s_waitcnt lgkmcnt(10)
    v_mfma_f32_16x16x32_bf16 v[92:95], v[32:35], v[52:55], v[92:95]
    ds_read_b64_tr_b16 v[72:73], v27 offset:61440
    s_cmp_eq_u32 s53, 0
    s_cbranch_scc0 L_rd_35
    s_add_u32 m0, s73, 4096
    s_nop 0
    buffer_load_dwordx4 v14, s[68:71], s76 offen  lds
L_rd_35:
    s_add_u32 s76, s76, s77
    v_mfma_f32_16x16x32_bf16 v[112:115], v[36:39], v[52:55], v[112:115]
    ds_read_b64_tr_b16 v[74:75], v27 offset:62720
    s_waitcnt lgkmcnt(10)
    v_mfma_f32_16x16x32_bf16 v[96:99], v[32:35], v[56:59], v[96:99]
    ds_read_b64_tr_b16 v[76:77], v28 offset:61440
    v_mfma_f32_16x16x32_bf16 v[116:119], v[36:39], v[56:59], v[116:119]
    ds_read_b64_tr_b16 v[78:79], v28 offset:62720
    s_cmp_eq_u32 s53, 0
    s_cbranch_scc0 L_rx_36
    s_waitcnt vmcnt(5)
    s_branch L_rd_37
L_rx_36:
    s_waitcnt vmcnt(4)
L_rd_37:
    s_barrier
    s_waitcnt lgkmcnt(8)
    v_mfma_f32_16x16x32_bf16 v[80:83], v[184:187], v[60:63], v[80:83]
    ds_read_b128 v[32:35], v15 offset:0
    ds_read_b128 v[36:39], v16 offset:0
    v_mfma_f32_16x16x32_bf16 v[100:103], v[188:191], v[60:63], v[100:103]
    ds_read_b64_tr_b16 v[40:41], v19 offset:0
    s_add_u32 m0, s74, 0
    s_nop 0
    buffer_load_dwordx4 v10, s[68:71], s76 offen  lds
    s_waitcnt lgkmcnt(9)
    v_mfma_f32_16x16x32_bf16 v[84:87], v[184:187], v[64:67], v[84:87]
    ds_read_b64_tr_b16 v[42:43], v19 offset:1280
    v_mfma_f32_16x16x32_bf16 v[104:107], v[188:191], v[64:67], v[104:107]
    ds_read_b64_tr_b16 v[44:45], v20 offset:0
    s_waitcnt lgkmcnt(9)
    v_mfma_f32_16x16x32_bf16 v[88:91], v[184:187], v[68:71], v[88:91]
    ds_read_b64_tr_b16 v[46:47], v20 offset:1280
    s_add_u32 m0, s74, 1024
    s_add_u32 s61, s76, s79
    buffer_load_dwordx4 v11, s[68:71], s61 offen  lds
    v_mfma_f32_16x16x32_bf16 v[108:111], v[188:191], v[68:71], v[108:111]
    ds_read_b64_tr_b16 v[48:49], v21 offset:0
    ds_read_b64_tr_b16 v[50:51], v21 offset:1280
    s_waitcnt lgkmcnt(10)
    v_mfma_f32_16x16x32_bf16 v[92:95], v[184:187], v[72:75], v[92:95]
    ds_read_b64_tr_b16 v[52:53], v22 offset:0
    v_mfma_f32_16x16x32_bf16 v[112:115], v[188:191], v[72:75], v[112:115]
    ds_read_b64_tr_b16 v[54:55], v22 offset:1280
    s_add_u32 m0, s74, 2048
    s_add_u32 s61, s76, s80
    buffer_load_dwordx4 v12, s[68:71], s61 offen  lds
    s_waitcnt lgkmcnt(10)
    v_mfma_f32_16x16x32_bf16 v[96:99], v[184:187], v[76:79], v[96:99]
    ds_read_b64_tr_b16 v[56:57], v23 offset:0
    v_mfma_f32_16x16x32_bf16 v[116:119], v[188:191], v[76:79], v[116:119]
    ds_read_b64_tr_b16 v[58:59], v23 offset:1280
    v_mul_u32_u24 v4, 52, v1
    v_lshrrev_b32 v4, 8, v4
    v_mul_u32_u24 v5, 5, v4
    v_sub_u32 v5, v1, v5
    s_mul_i32 s54, s22, 20
    v_add_u32 v4, s54, v4
    s_movk_i32 s55, 1280
    v_mul_u32_u24 v4, s55, v4
    v_lshl_add_u32 v4, v5, 7, v4
    s_lshr_b32 s54, s50, 2
    s_mul_i32 s54, s54, 640
    v_add_u32 v29, s54, v4
    s_waitcnt lgkmcnt(8)
    v_mfma_f32_16x16x32_bf16 v[80:83], v[32:35], v[40:43], v[80:83]
    ds_read_b128 v[192:195], v17 offset:0
    ds_read_b128 v[196:199], v18 offset:0
    v_mfma_f32_16x16x32_bf16 v[100:103], v[36:39], v[40:43], v[100:103]
    ds_read_b64_tr_b16 v[60:61], v24 offset:0
    s_waitcnt lgkmcnt(9)
    v_mfma_f32_16x16x32_bf16 v[84:87], v[32:35], v[44:47], v[84:87]
    ds_read_b64_tr_b16 v[62:63], v24 offset:1280
    s_add_u32 m0, s74, 3072
    s_add_u32 s61, s76, s81
    buffer_load_dwordx4 v13, s[68:71], s61 offen  lds
    v_mfma_f32_16x16x32_bf16 v[104:107], v[36:39], v[44:47], v[104:107]
    ds_read_b64_tr_b16 v[64:65], v25 offset:0
    s_waitcnt lgkmcnt(9)
    v_mfma_f32_16x16x32_bf16 v[88:91], v[32:35], v[48:51], v[88:91]
    ds_read_b64_tr_b16 v[66:67], v25 offset:1280
    v_mfma_f32_16x16x32_bf16 v[108:111], v[36:39], v[48:51], v[108:111]
    ds_read_b64_tr_b16 v[68:69], v26 offset:0
    ds_read_b64_tr_b16 v[70:71], v26 offset:1280
    s_waitcnt lgkmcnt(10)
    v_mfma_f32_16x16x32_bf16 v[92:95], v[32:35], v[52:55], v[92:95]
    ds_read_b64_tr_b16 v[72:73], v27 offset:0
    s_cmp_eq_u32 s53, 0
    s_cbranch_scc0 L_rd_39
    s_add_u32 m0, s74, 4096
    s_nop 0
    buffer_load_dwordx4 v14, s[68:71], s76 offen  lds
L_rd_39:
    s_add_u32 s76, s76, s77
    v_mfma_f32_16x16x32_bf16 v[112:115], v[36:39], v[52:55], v[112:115]
    ds_read_b64_tr_b16 v[74:75], v27 offset:1280
    s_waitcnt lgkmcnt(10)
    v_mfma_f32_16x16x32_bf16 v[96:99], v[32:35], v[56:59], v[96:99]
    ds_read_b64_tr_b16 v[76:77], v28 offset:0
    v_mfma_f32_16x16x32_bf16 v[116:119], v[36:39], v[56:59], v[116:119]
    ds_read_b64_tr_b16 v[78:79], v28 offset:1280
    s_cmp_eq_u32 s53, 0
    s_cbranch_scc0 L_rx_40
    s_waitcnt vmcnt(5)
    s_branch L_rd_41
L_rx_40:
    s_waitcnt vmcnt(4)
L_rd_41:
    s_barrier
    s_waitcnt lgkmcnt(8)
    v_mfma_f32_16x16x32_bf16 v[80:83], v[192:195], v[60:63], v[80:83]
    ds_read_b128 v[32:35], v15 offset:16384
    ds_read_b128 v[36:39], v16 offset:16384
    v_mfma_f32_16x16x32_bf16 v[100:103], v[196:199], v[60:63], v[100:103]
    ds_read_b64_tr_b16 v[40:41], v19 offset:20480
    s_add_u32 m0, s75, 0
    s_nop 0
    buffer_load_dwordx4 v10, s[68:71], s76 offen  lds
    s_waitcnt lgkmcnt(9)
    v_mfma_f32_16x16x32_bf16 v[84:87], v[192:195], v[64:67], v[84:87]
    ds_read_b64_tr_b16 v[42:43], v19 offset:21760
    v_mfma_f32_16x16x32_bf16 v[104:107], v[196:199], v[64:67], v[104:107]
    ds_read_b64_tr_b16 v[44:45], v20 offset:20480
    s_waitcnt lgkmcnt(9)
    v_mfma_f32_16x16x32_bf16 v[88:91], v[192:195], v[68:71], v[88:91]
    ds_read_b64_tr_b16 v[46:47], v20 offset:21760
    s_add_u32 m0, s75, 1024
    s_add_u32 s61, s76, s79
    buffer_load_dwordx4 v11, s[68:71], s61 offen  lds
    v_mfma_f32_16x16x32_bf16 v[108:111], v[196:199], v[68:71], v[108:111]
    ds_read_b64_tr_b16 v[48:49], v21 offset:20480
    ds_read_b64_tr_b16 v[50:51], v21 offset:21760
    s_waitcnt lgkmcnt(10)
    v_mfma_f32_16x16x32_bf16 v[92:95], v[192:195], v[72:75], v[92:95]
    ds_read_b64_tr_b16 v[52:53], v22 offset:20480
    v_mfma_f32_16x16x32_bf16 v[112:115], v[196:199], v[72:75], v[112:115]
    ds_read_b64_tr_b16 v[54:55], v22 offset:21760
    s_add_u32 m0, s75, 2048
    s_add_u32 s61, s76, s80
    buffer_load_dwordx4 v12, s[68:71], s61 offen  lds
    s_waitcnt lgkmcnt(10)
    v_mfma_f32_16x16x32_bf16 v[96:99], v[192:195], v[76:79], v[96:99]
    ds_read_b64_tr_b16 v[56:57], v23 offset:20480
    v_mfma_f32_16x16x32_bf16 v[116:119], v[196:199], v[76:79], v[116:119]
    ds_read_b64_tr_b16 v[58:59], v23 offset:21760
    s_cmp_eq_u32 s51, 1
    s_cbranch_scc0 L_ow_42
    s_mov_b32 s61, 0
    buffer_load_dword v245, v31, s[28:31], s61 offen
L_ow_42:
    s_cmp_eq_u32 s51, 5
    s_cbranch_scc0 L_ow_43
    s_cmp_eq_u32 s48, 0
    s_cbranch_scc1 L_wpf_44
    buffer_load_dword v245, v29, s[44:47], 0 offen
    s_mov_b32 s61, 15360
    buffer_load_dword v245, v29, s[44:47], s61 offen
    s_branch L_wpf2_45
L_wpf_44:
    buffer_load_dword v245, v29, s[40:43], 0 offen
    s_mov_b32 s61, 15360
    buffer_load_dword v245, v29, s[40:43], s61 offen
L_wpf2_45:
L_ow_43:
    s_waitcnt lgkmcnt(8)
    v_mfma_f32_16x16x32_bf16 v[80:83], v[32:35], v[40:43], v[80:83]
    ds_read_b128 v[200:203], v17 offset:16384
    ds_read_b128 v[204:207], v18 offset:16384
    v_mfma_f32_16x16x32_bf16 v[100:103], v[36:39], v[40:43], v[100:103]
    ds_read_b64_tr_b16 v[60:61], v24 offset:20480
    s_mul_i32 s55, s53, 10240
    s_add_u32 s58, s55, 0
    v_add_u32 v246, s58, v122
    s_add_u32 s58, s55, 40
    s_waitcnt lgkmcnt(9)
    v_mfma_f32_16x16x32_bf16 v[84:87], v[32:35], v[44:47], v[84:87]
    ds_read_b64_tr_b16 v[62:63], v24 offset:21760
    s_add_u32 m0, s75, 3072
    s_add_u32 s61, s76, s81
    buffer_load_dwordx4 v13, s[68:71], s61 offen  lds
    v_mfma_f32_16x16x32_bf16 v[104:107], v[36:39], v[44:47], v[104:107]
    ds_read_b64_tr_b16 v[64:65], v25 offset:20480
    v_add_u32 v247, s58, v122
    s_add_u32 s58, s55, 80
    v_add_u32 v248, s58, v122
    s_add_u32 s58, s55, 120
    s_waitcnt lgkmcnt(9)
    v_mfma_f32_16x16x32_bf16 v[88:91], v[32:35], v[48:51], v[88:91]
    ds_read_b64_tr_b16 v[66:67], v25 offset:21760
    v_add_u32 v249, s58, v122
    s_add_u32 s58, s55, 160
    v_add_u32 v251, s58, v122
    s_add_u32 s58, s55, 200
    v_mfma_f32_16x16x32_bf16 v[108:111], v[36:39], v[48:51], v[108:111]
    ds_read_b64_tr_b16 v[68:69], v26 offset:20480
    ds_read_b64_tr_b16 v[70:71], v26 offset:21760
    v_add_u32 v252, s58, v122
    s_add_u32 s58, s55, 240
    v_add_u32 v253, s58, v122
    v_add_u32 v5, 280, v120
    s_waitcnt lgkmcnt(10)
    v_mfma_f32_16x16x32_bf16 v[92:95], v[32:35], v[52:55], v[92:95]
    ds_read_b64_tr_b16 v[72:73], v27 offset:20480
    s_cmp_eq_u32 s53, 0
    s_cbranch_scc0 L_rd_47
    s_add_u32 m0, s75, 4096
    s_nop 0
    buffer_load_dwordx4 v14, s[68:71], s76 offen  lds
L_rd_47:
    s_add_u32 s76, s76, s77
    v_mfma_f32_16x16x32_bf16 v[112:115], v[36:39], v[52:55], v[112:115]
    ds_read_b64_tr_b16 v[74:75], v27 offset:21760
    v_subrev_u32 v124, 320, v5
    v_min_u32 v5, v5, v124
    v_add3_u32 v254, v5, v121, s55
    s_add_u32 s58, s55, 32
    s_waitcnt lgkmcnt(10)
    v_mfma_f32_16x16x32_bf16 v[96:99], v[32:35], v[56:59], v[96:99]
    ds_read_b64_tr_b16 v[76:77], v28 offset:20480
    v_add3_u32 v250, v123, v121, s58
    v_add_u32 v5, 192, v123
    v_subrev_u32 v124, 320, v5
    v_min_u32 v5, v5, v124
    v_mfma_f32_16x16x32_bf16 v[116:119], v[36:39], v[56:59], v[116:119]
    ds_read_b64_tr_b16 v[78:79], v28 offset:21760
    v_add3_u32 v255, v5, v121, s55
    v_lshl_add_u32 v4, v3, 2, v2
    v_and_b32 v4, 15, v4
    v_lshl_add_u32 v4, v3, 4, v4
    v_lshlrev_b32 v0, 4, v4
    s_cmp_eq_u32 s53, 0
    s_cbranch_scc0 L_rx_48
    s_waitcnt vmcnt(5)
    s_branch L_rd_49
L_rx_48:
    s_waitcnt vmcnt(4)
L_rd_49:
    s_barrier
    s_waitcnt lgkmcnt(8)
    v_mfma_f32_16x16x32_bf16 v[80:83], v[200:203], v[60:63], v[80:83]
    ds_read_b128 v[32:35], v15 offset:32768
    ds_read_b128 v[36:39], v16 offset:32768
    v_mfma_f32_16x16x32_bf16 v[100:103], v[204:207], v[60:63], v[100:103]
    ds_read_b64_tr_b16 v[40:41], v19 offset:40960
    s_add_u32 m0, s72, 0
    s_nop 0
    buffer_load_dwordx4 v10, s[68:71], s76 offen  lds
    s_waitcnt lgkmcnt(9)
    v_mfma_f32_16x16x32_bf16 v[84:87], v[200:203], v[64:67], v[84:87]
    ds_read_b64_tr_b16 v[42:43], v19 offset:42240
    v_mfma_f32_16x16x32_bf16 v[104:107], v[204:207], v[64:67], v[104:107]
    ds_read_b64_tr_b16 v[44:45], v20 offset:40960
    s_waitcnt lgkmcnt(9)
    v_mfma_f32_16x16x32_bf16 v[88:91], v[200:203], v[68:71], v[88:91]
    ds_read_b64_tr_b16 v[46:47], v20 offset:42240
    s_add_u32 m0, s72, 1024
    s_add_u32 s61, s76, s79
    buffer_load_dwordx4 v11, s[68:71], s61 offen  lds
    v_mfma_f32_16x16x32_bf16 v[108:111], v[204:207], v[68:71], v[108:111]
    ds_read_b64_tr_b16 v[48:49], v21 offset:40960
    ds_read_b64_tr_b16 v[50:51], v21 offset:42240
    s_waitcnt lgkmcnt(10)
    v_mfma_f32_16x16x32_bf16 v[92:95], v[200:203], v[72:75], v[92:95]
    ds_read_b64_tr_b16 v[52:53], v22 offset:40960
    v_mfma_f32_16x16x32_bf16 v[112:115], v[204:207], v[72:75], v[112:115]
    ds_read_b64_tr_b16 v[54:55], v22 offset:42240
    s_add_u32 m0, s72, 2048
    s_add_u32 s61, s76, s80
    buffer_load_dwordx4 v12, s[68:71], s61 offen  lds
    s_waitcnt lgkmcnt(10)
    v_mfma_f32_16x16x32_bf16 v[96:99], v[200:203], v[76:79], v[96:99]
    ds_read_b64_tr_b16 v[56:57], v23 offset:40960
    v_mfma_f32_16x16x32_bf16 v[116:119], v[204:207], v[76:79], v[116:119]
    ds_read_b64_tr_b16 v[58:59], v23 offset:42240
    s_cmp_eq_u32 s51, 2
    s_cbranch_scc0 L_ow_50
    s_mov_b32 s61, 983040
    buffer_load_dword v245, v31, s[28:31], s61 offen
L_ow_50:
    s_waitcnt lgkmcnt(8)
    v_mfma_f32_16x16x32_bf16 v[80:83], v[32:35], v[40:43], v[80:83]
    ds_read_b128 v[208:211], v17 offset:32768
    ds_read_b128 v[212:215], v18 offset:32768
    v_mfma_f32_16x16x32_bf16 v[100:103], v[36:39], v[40:43], v[100:103]
    ds_read_b64_tr_b16 v[60:61], v24 offset:40960
    s_waitcnt lgkmcnt(9)
    v_mfma_f32_16x16x32_bf16 v[84:87], v[32:35], v[44:47], v[84:87]
    ds_read_b64_tr_b16 v[62:63], v24 offset:42240
    s_add_u32 m0, s72, 3072
    s_add_u32 s61, s76, s81
    buffer_load_dwordx4 v13, s[68:71], s61 offen  lds
    v_mfma_f32_16x16x32_bf16 v[104:107], v[36:39], v[44:47], v[104:107]
    ds_read_b64_tr_b16 v[64:65], v25 offset:40960
    s_waitcnt lgkmcnt(9)
    v_mfma_f32_16x16x32_bf16 v[88:91], v[32:35], v[48:51], v[88:91]
    ds_read_b64_tr_b16 v[66:67], v25 offset:42240
    v_mfma_f32_16x16x32_bf16 v[108:111], v[36:39], v[48:51], v[108:111]
    ds_read_b64_tr_b16 v[68:69], v26 offset:40960
    ds_read_b64_tr_b16 v[70:71], v26 offset:42240
    s_waitcnt lgkmcnt(10)
    v_mfma_f32_16x16x32_bf16 v[92:95], v[32:35], v[52:55], v[92:95]
    ds_read_b64_tr_b16 v[72:73], v27 offset:40960
    s_cmp_eq_u32 s53, 0
    s_cbranch_scc0 L_rd_52
    s_add_u32 m0, s72, 4096
    s_nop 0
    buffer_load_dwordx4 v14, s[68:71], s76 offen  lds
L_rd_52:
    s_add_u32 s76, s76, s77
    v_mfma_f32_16x16x32_bf16 v[112:115], v[36:39], v[52:55], v[112:115]
    ds_read_b64_tr_b16 v[74:75], v27 offset:42240
    s_waitcnt lgkmcnt(10)
    v_mfma_f32_16x16x32_bf16 v[96:99], v[32:35], v[56:59], v[96:99]
    ds_read_b64_tr_b16 v[76:77], v28 offset:40960
    v_mfma_f32_16x16x32_bf16 v[116:119], v[36:39], v[56:59], v[116:119]
    ds_read_b64_tr_b16 v[78:79], v28 offset:42240
    s_cmp_eq_u32 s53, 0
    s_cbranch_scc0 L_rx_53
    s_waitcnt vmcnt(5)
    s_branch L_rd_54
L_rx_53:
    s_waitcnt vmcnt(4)
L_rd_54:
    s_barrier
    s_waitcnt lgkmcnt(8)
    v_mfma_f32_16x16x32_bf16 v[80:83], v[208:211], v[60:63], v[80:83]
    ds_read_b128 v[32:35], v15 offset:49152
    ds_read_b128 v[36:39], v16 offset:49152
    v_mfma_f32_16x16x32_bf16 v[100:103], v[212:215], v[60:63], v[100:103]
    ds_read_b64_tr_b16 v[40:41], v19 offset:61440
    s_add_u32 m0, s73, 0
    s_nop 0
    buffer_load_dwordx4 v10, s[68:71], s76 offen  lds
    s_waitcnt lgkmcnt(9)
    v_mfma_f32_16x16x32_bf16 v[84:87], v[208:211], v[64:67], v[84:87]
    ds_read_b64_tr_b16 v[42:43], v19 offset:62720
    v_mfma_f32_16x16x32_bf16 v[104:107], v[212:215], v[64:67], v[104:107]
    ds_read_b64_tr_b16 v[44:45], v20 offset:61440
    s_waitcnt lgkmcnt(9)
    v_mfma_f32_16x16x32_bf16 v[88:91], v[208:211], v[68:71], v[88:91]
    ds_read_b64_tr_b16 v[46:47], v20 offset:62720
    s_add_u32 m0, s73, 1024
    s_add_u32 s61, s76, s79
    buffer_load_dwordx4 v11, s[68:71], s61 offen  lds
    v_mfma_f32_16x16x32_bf16 v[108:111], v[212:215], v[68:71], v[108:111]
    ds_read_b64_tr_b16 v[48:49], v21 offset:61440
    ds_read_b64_tr_b16 v[50:51], v21 offset:62720
    s_waitcnt lgkmcnt(10)
    v_mfma_f32_16x16x32_bf16 v[92:95], v[208:211], v[72:75], v[92:95]
    ds_read_b64_tr_b16 v[52:53], v22 offset:61440
    v_mfma_f32_16x16x32_bf16 v[112:115], v[212:215], v[72:75], v[112:115]
    ds_read_b64_tr_b16 v[54:55], v22 offset:62720
    s_add_u32 m0, s73, 2048
    s_add_u32 s61, s76, s80
    buffer_load_dwordx4 v12, s[68:71], s61 offen  lds
    s_waitcnt lgkmcnt(10)
    v_mfma_f32_16x16x32_bf16 v[96:99], v[208:211], v[76:79], v[96:99]
    ds_read_b64_tr_b16 v[56:57], v23 offset:61440
    v_mfma_f32_16x16x32_bf16 v[116:119], v[212:215], v[76:79], v[116:119]
    ds_read_b64_tr_b16 v[58:59], v23 offset:62720
    s_cmp_eq_u32 s51, 3
    s_cbranch_scc0 L_ow_55
    s_mov_b32 s61, 1966080
    buffer_load_dword v245, v31, s[28:31], s61 offen
L_ow_55:
    s_waitcnt lgkmcnt(8)
    v_mfma_f32_16x16x32_bf16 v[80:83], v[32:35], v[40:43], v[80:83]
    ds_read_b128 v[216:219], v17 offset:49152
    ds_read_b128 v[220:223], v18 offset:49152
    s_mul_i32 s54, s51, 7168
    v_lshlrev_b32 v4, 4, v1
    v_add_u32 v136, s54, v4
    s_and_b32 s54, s51, 1
    s_lshl_b32 s54, s54, 6
    v_add_u32 v5, s54, v1
    v_mfma_f32_16x16x32_bf16 v[100:103], v[36:39], v[40:43], v[100:103]
    ds_read_b64_tr_b16 v[60:61], v24 offset:61440
    s_movk_i32 s55, 2731
    v_mul_u32_u24 v6, s55, v5
    v_lshrrev_b32 v6, 16, v6
    v_mul_u32_u24 v7, 24, v6
    v_sub_u32 v7, v5, v7
    s_lshr_b32 s56, s51, 1
    s_waitcnt lgkmcnt(9)
    v_mfma_f32_16x16x32_bf16 v[84:87], v[32:35], v[44:47], v[84:87]
    ds_read_b64_tr_b16 v[62:63], v24 offset:62720
    s_add_u32 m0, s73, 3072
    s_add_u32 s61, s76, s81
    buffer_load_dwordx4 v13, s[68:71], s61 offen  lds
    v_mfma_f32_16x16x32_bf16 v[104:107], v[36:39], v[44:47], v[104:107]
    ds_read_b64_tr_b16 v[64:65], v25 offset:61440
    s_and_b32 s57, s56, 1
    s_lshr_b32 s56, s56, 1
    s_lshl_b32 s58, s57, 2
    s_sub_u32 s58, s58, 8
    v_add_u32 v8, s58, v7
    v_cmp_gt_u32_e64 s[62:63], 20, v7
    s_waitcnt lgkmcnt(9)
    v_mfma_f32_16x16x32_bf16 v[88:91], v[32:35], v[48:51], v[88:91]
    ds_read_b64_tr_b16 v[66:67], v25 offset:62720
    v_cmp_gt_u32_e64 s[64:65], 16, v7
    v_cmp_gt_u32_e64 s[66:67], 4, v6
    s_nop 1
    v_cndmask_b32_e64 v8, 0, v8, s[62:63]
    v_cndmask_b32_e64 v8, v8, v7, s[64:65]
    v_mov_b32 v4, s57
    v_cndmask_b32_e64 v4, v4, v6, s[66:67]
    v_mfma_f32_16x16x32_bf16 v[108:111], v[36:39], v[48:51], v[108:111]
    ds_read_b64_tr_b16 v[68:69], v26 offset:61440
    ds_read_b64_tr_b16 v[70:71], v26 offset:62720
    v_lshl_add_u32 v8, v4, 4, v8
    s_add_u32 s58, s57, 4
    v_mov_b32 v4, s58
    v_mov_b32 v139, s57
    v_cndmask_b32_e64 v4, v4, v139, s[66:67]
    s_add_u32 s58, s57, 2
    s_waitcnt lgkmcnt(10)
    v_mfma_f32_16x16x32_bf16 v[92:95], v[32:35], v[52:55], v[92:95]
    ds_read_b64_tr_b16 v[72:73], v27 offset:61440
    s_cmp_eq_u32 s53, 0
    s_cbranch_scc0 L_rd_57
    s_add_u32 m0, s73, 4096
    s_nop 0
    buffer_load_dwordx4 v14, s[68:71], s76 offen  lds
L_rd_57:
    s_add_u32 s76, s76, s77
    v_mfma_f32_16x16x32_bf16 v[112:115], v[36:39], v[52:55], v[112:115]
    ds_read_b64_tr_b16 v[74:75], v27 offset:62720
    v_mov_b32 v139, s58
    v_cndmask_b32_e64 v139, 6, v139, s[66:67]
    v_cndmask_b32_e64 v4, v139, v4, s[64:65]
    v_lshlrev_b32 v4, 10, v4
    v_lshl_add_u32 v8, v8, 4, v4
    s_mul_i32 s58, s56, 28672
    s_waitcnt lgkmcnt(10)
    v_mfma_f32_16x16x32_bf16 v[96:99], v[32:35], v[56:59], v[96:99]
    ds_read_b64_tr_b16 v[76:77], v28 offset:61440
    v_add_u32 v8, s58, v8
    v_cmp_gt_u32_e64 s[62:63], 21, v7
    v_cmp_gt_u32_e64 s[64:65], 5, v6
    v_min_u32 v137, 35824, v8
    s_lshl_b32 s92, s50, 4
    s_add_u32 s92, s92, s49
    v_mfma_f32_16x16x32_bf16 v[116:119], v[36:39], v[56:59], v[116:119]
    ds_read_b64_tr_b16 v[78:79], v28 offset:62720
    s_lshl_b32 s92, s92, 12
    s_lshr_b32 s55, s51, 1
    s_lshl_b32 s55, s55, 10
    s_add_u32 s92, s92, s55
    s_add_u32 s92, s92, 15728640
    v_lshlrev_b32 v138, 3, v5
    s_and_b64 s[90:91], s[62:63], s[64:65]
    s_cmp_eq_u32 s53, 0
    s_cbranch_scc0 L_rx_58
    s_waitcnt vmcnt(5)
    s_branch L_rd_59
L_rx_58:
    s_waitcnt vmcnt(4)
L_rd_59:
    s_barrier
    s_waitcnt lgkmcnt(8)
    v_mfma_f32_16x16x32_bf16 v[80:83], v[216:219], v[60:63], v[80:83]
    ds_read_b128 v[32:35], v15 offset:0
    ds_read_b128 v[36:39], v16 offset:0
    v_mfma_f32_16x16x32_bf16 v[100:103], v[220:223], v[60:63], v[100:103]
    ds_read_b64_tr_b16 v[40:41], v19 offset:0
    s_cmp_eq_u32 s53, 0
    s_cbranch_scc0 L_rd_61
    s_add_u32 m0, s74, 0
    s_mov_b32 s61, 0
    buffer_load_dwordx4 v240, s[68:71], s61 offen  lds
L_rd_61:
    s_waitcnt lgkmcnt(9)
    v_mfma_f32_16x16x32_bf16 v[84:87], v[216:219], v[64:67], v[84:87]
    ds_read_b64_tr_b16 v[42:43], v19 offset:1280
    v_mfma_f32_16x16x32_bf16 v[104:107], v[220:223], v[64:67], v[104:107]
    ds_read_b64_tr_b16 v[44:45], v20 offset:0
    s_waitcnt lgkmcnt(9)
    v_mfma_f32_16x16x32_bf16 v[88:91], v[216:219], v[68:71], v[88:91]
    ds_read_b64_tr_b16 v[46:47], v20 offset:1280
    s_cmp_eq_u32 s53, 0
    s_cbranch_scc0 L_rd_63
    s_add_u32 m0, s74, 1024
    s_mov_b32 s61, 0
    buffer_load_dwordx4 v241, s[68:71], s61 offen  lds
L_rd_63:
    v_mfma_f32_16x16x32_bf16 v[108:111], v[220:223], v[68:71], v[108:111]
    ds_read_b64_tr_b16 v[48:49], v21 offset:0
    ds_read_b64_tr_b16 v[50:51], v21 offset:1280
    s_waitcnt lgkmcnt(10)
    v_mfma_f32_16x16x32_bf16 v[92:95], v[216:219], v[72:75], v[92:95]
    ds_read_b64_tr_b16 v[52:53], v22 offset:0
    v_mfma_f32_16x16x32_bf16 v[112:115], v[220:223], v[72:75], v[112:115]
    ds_read_b64_tr_b16 v[54:55], v22 offset:1280
    s_cmp_eq_u32 s53, 0
    s_cbranch_scc0 L_rd_65
    s_add_u32 m0, s74, 2048
    s_mov_b32 s61, 0
    buffer_load_dwordx4 v242, s[68:71], s61 offen  lds
L_rd_65:
    s_waitcnt lgkmcnt(10)
    v_mfma_f32_16x16x32_bf16 v[96:99], v[216:219], v[76:79], v[96:99]
    ds_read_b64_tr_b16 v[56:57], v23 offset:0
    v_mfma_f32_16x16x32_bf16 v[116:119], v[220:223], v[76:79], v[116:119]
    ds_read_b64_tr_b16 v[58:59], v23 offset:1280
    s_waitcnt lgkmcnt(8)
    v_mfma_f32_16x16x32_bf16 v[80:83], v[32:35], v[40:43], v[80:83]
    ds_read_b128 v[224:227], v17 offset:0
    ds_read_b128 v[228:231], v18 offset:0
    v_mfma_f32_16x16x32_bf16 v[100:103], v[36:39], v[40:43], v[100:103]
    ds_read_b64_tr_b16 v[60:61], v24 offset:0
    s_waitcnt lgkmcnt(9)
    v_mfma_f32_16x16x32_bf16 v[84:87], v[32:35], v[44:47], v[84:87]
    ds_read_b64_tr_b16 v[62:63], v24 offset:1280
    s_cmp_eq_u32 s53, 0
    s_cbranch_scc0 L_rd_67
    s_add_u32 m0, s74, 3072
    s_mov_b32 s61, 0
    buffer_load_dwordx4 v243, s[68:71], s61 offen  lds
L_rd_67:
    v_mfma_f32_16x16x32_bf16 v[104:107], v[36:39], v[44:47], v[104:107]
    ds_read_b64_tr_b16 v[64:65], v25 offset:0
    s_waitcnt lgkmcnt(9)
    v_mfma_f32_16x16x32_bf16 v[88:91], v[32:35], v[48:51], v[88:91]
    ds_read_b64_tr_b16 v[66:67], v25 offset:1280
    v_mfma_f32_16x16x32_bf16 v[108:111], v[36:39], v[48:51], v[108:111]
    ds_read_b64_tr_b16 v[68:69], v26 offset:0
    ds_read_b64_tr_b16 v[70:71], v26 offset:1280
    s_waitcnt lgkmcnt(10)
    v_mfma_f32_16x16x32_bf16 v[92:95], v[32:35], v[52:55], v[92:95]
    ds_read_b64_tr_b16 v[72:73], v27 offset:0
    s_cmp_eq_u32 s53, 0
    s_cbranch_scc0 L_rd_69
    s_add_u32 m0, s74, 4096
    s_mov_b32 s61, 0
    buffer_load_dwordx4 v244, s[68:71], s61 offen  lds
L_rd_69:
    v_mfma_f32_16x16x32_bf16 v[112:115], v[36:39], v[52:55], v[112:115]
    ds_read_b64_tr_b16 v[74:75], v27 offset:1280
    s_waitcnt lgkmcnt(10)
    v_mfma_f32_16x16x32_bf16 v[96:99], v[32:35], v[56:59], v[96:99]
    ds_read_b64_tr_b16 v[76:77], v28 offset:0
    v_mfma_f32_16x16x32_bf16 v[116:119], v[36:39], v[56:59], v[116:119]
    ds_read_b64_tr_b16 v[78:79], v28 offset:1280
    s_cmp_eq_u32 s53, 0
    s_cbranch_scc0 L_rx_70
    s_waitcnt vmcnt(5)
    s_branch L_rd_71
L_rx_70:
    s_waitcnt vmcnt(0)
L_rd_71:
    s_barrier
    s_waitcnt lgkmcnt(8)
    v_mfma_f32_16x16x32_bf16 v[80:83], v[224:227], v[60:63], v[80:83]
    ds_read_b128 v[32:35], v15 offset:16384
    ds_read_b128 v[36:39], v16 offset:16384
    v_mfma_f32_16x16x32_bf16 v[100:103], v[228:231], v[60:63], v[100:103]
    ds_read_b64_tr_b16 v[40:41], v19 offset:20480
    s_cmp_eq_u32 s53, 0
    s_cbranch_scc0 L_rd_73
    s_add_u32 m0, s75, 0
    s_mov_b32 s61, 491520
    buffer_load_dwordx4 v240, s[68:71], s61 offen  lds
L_rd_73:
    s_waitcnt lgkmcnt(9)
    v_mfma_f32_16x16x32_bf16 v[84:87], v[224:227], v[64:67], v[84:87]
    ds_read_b64_tr_b16 v[42:43], v19 offset:21760
    v_mfma_f32_16x16x32_bf16 v[104:107], v[228:231], v[64:67], v[104:107]
    ds_read_b64_tr_b16 v[44:45], v20 offset:20480
    s_waitcnt lgkmcnt(9)
    v_mfma_f32_16x16x32_bf16 v[88:91], v[224:227], v[68:71], v[88:91]
    ds_read_b64_tr_b16 v[46:47], v20 offset:21760
    s_cmp_eq_u32 s53, 0
    s_cbranch_scc0 L_rd_75
    s_add_u32 m0, s75, 1024
    s_mov_b32 s61, 491520
    buffer_load_dwordx4 v241, s[68:71], s61 offen  lds
L_rd_75:
    v_mfma_f32_16x16x32_bf16 v[108:111], v[228:231], v[68:71], v[108:111]
    ds_read_b64_tr_b16 v[48:49], v21 offset:20480
    ds_read_b64_tr_b16 v[50:51], v21 offset:21760
    s_waitcnt lgkmcnt(10)
    v_mfma_f32_16x16x32_bf16 v[92:95], v[224:227], v[72:75], v[92:95]
    ds_read_b64_tr_b16 v[52:53], v22 offset:20480
    v_mfma_f32_16x16x32_bf16 v[112:115], v[228:231], v[72:75], v[112:115]
    ds_read_b64_tr_b16 v[54:55], v22 offset:21760
    s_cmp_eq_u32 s53, 0
    s_cbranch_scc0 L_rd_77
    s_add_u32 m0, s75, 2048
    s_mov_b32 s61, 491520
    buffer_load_dwordx4 v242, s[68:71], s61 offen  lds
L_rd_77:
    s_waitcnt lgkmcnt(10)
    v_mfma_f32_16x16x32_bf16 v[96:99], v[224:227], v[76:79], v[96:99]
    ds_read_b64_tr_b16 v[56:57], v23 offset:20480
    v_mfma_f32_16x16x32_bf16 v[116:119], v[228:231], v[76:79], v[116:119]
    ds_read_b64_tr_b16 v[58:59], v23 offset:21760
    s_waitcnt lgkmcnt(8)
    v_mfma_f32_16x16x32_bf16 v[80:83], v[32:35], v[40:43], v[80:83]
    ds_read_b128 v[232:235], v17 offset:16384
    ds_read_b128 v[236:239], v18 offset:16384
    v_mfma_f32_16x16x32_bf16 v[100:103], v[36:39], v[40:43], v[100:103]
    ds_read_b64_tr_b16 v[60:61], v24 offset:20480
    s_waitcnt lgkmcnt(9)
    v_mfma_f32_16x16x32_bf16 v[84:87], v[32:35], v[44:47], v[84:87]
    ds_read_b64_tr_b16 v[62:63], v24 offset:21760
    s_cmp_eq_u32 s53, 0
    s_cbranch_scc0 L_rd_79
    s_add_u32 m0, s75, 3072
    s_mov_b32 s61, 491520
    buffer_load_dwordx4 v243, s[68:71], s61 offen  lds
L_rd_79:
    v_mfma_f32_16x16x32_bf16 v[104:107], v[36:39], v[44:47], v[104:107]
    ds_read_b64_tr_b16 v[64:65], v25 offset:20480
    s_waitcnt lgkmcnt(9)
    v_mfma_f32_16x16x32_bf16 v[88:91], v[32:35], v[48:51], v[88:91]
    ds_read_b64_tr_b16 v[66:67], v25 offset:21760
    v_mfma_f32_16x16x32_bf16 v[108:111], v[36:39], v[48:51], v[108:111]
    ds_read_b64_tr_b16 v[68:69], v26 offset:20480
    ds_read_b64_tr_b16 v[70:71], v26 offset:21760
    s_waitcnt lgkmcnt(10)
    v_mfma_f32_16x16x32_bf16 v[92:95], v[32:35], v[52:55], v[92:95]
    ds_read_b64_tr_b16 v[72:73], v27 offset:20480
    s_cmp_eq_u32 s53, 0
    s_cbranch_scc0 L_rd_81
    s_add_u32 m0, s75, 4096
    s_mov_b32 s61, 491520
    buffer_load_dwordx4 v244, s[68:71], s61 offen  lds
L_rd_81:
    v_mfma_f32_16x16x32_bf16 v[112:115], v[36:39], v[52:55], v[112:115]
    ds_read_b64_tr_b16 v[74:75], v27 offset:21760
    s_waitcnt lgkmcnt(10)
    v_mfma_f32_16x16x32_bf16 v[96:99], v[32:35], v[56:59], v[96:99]
    ds_read_b64_tr_b16 v[76:77], v28 offset:20480
    v_mfma_f32_16x16x32_bf16 v[116:119], v[36:39], v[56:59], v[116:119]
    ds_read_b64_tr_b16 v[78:79], v28 offset:21760
    s_waitcnt vmcnt(5)
    s_barrier
    s_waitcnt lgkmcnt(8)
    v_mfma_f32_16x16x32_bf16 v[80:83], v[232:235], v[60:63], v[80:83]
    ds_read_b64_tr_b16 v[40:41], v246 offset:40960
    ds_read_b64_tr_b16 v[42:43], v246 offset:42240
    v_mfma_f32_16x16x32_bf16 v[100:103], v[236:239], v[60:63], v[100:103]
    ds_read_b64_tr_b16 v[44:45], v247 offset:40960
    s_cmp_eq_u32 s53, 0
    s_cbranch_scc0 L_rd_83
    s_add_u32 m0, s72, 0
    s_mov_b32 s61, 983040
    buffer_load_dwordx4 v240, s[68:71], s61 offen  lds
L_rd_83:
    s_waitcnt lgkmcnt(9)
    v_mfma_f32_16x16x32_bf16 v[84:87], v[232:235], v[64:67], v[84:87]
    ds_read_b64_tr_b16 v[46:47], v247 offset:42240
    v_mfma_f32_16x16x32_bf16 v[104:107], v[236:239], v[64:67], v[104:107]
    ds_read_b64_tr_b16 v[48:49], v248 offset:40960
    s_cmp_eq_u32 s53, 0
    s_cbranch_scc0 L_rd_85
    s_add_u32 m0, s72, 1024
    s_mov_b32 s61, 983040
    buffer_load_dwordx4 v241, s[68:71], s61 offen  lds
L_rd_85:
    s_waitcnt lgkmcnt(9)
    v_mfma_f32_16x16x32_bf16 v[88:91], v[232:235], v[68:71], v[88:91]
    ds_read_b64_tr_b16 v[50:51], v248 offset:42240
    v_mfma_f32_16x16x32_bf16 v[108:111], v[236:239], v[68:71], v[108:111]
    ds_read_b64_tr_b16 v[52:53], v249 offset:40960
    ds_read_b64_tr_b16 v[54:55], v249 offset:42240
    s_cmp_eq_u32 s53, 0
    s_cbranch_scc0 L_rd_87
    s_add_u32 m0, s72, 2048
    s_mov_b32 s61, 983040
    buffer_load_dwordx4 v242, s[68:71], s61 offen  lds
L_rd_87:
    s_waitcnt lgkmcnt(10)
    v_mfma_f32_16x16x32_bf16 v[92:95], v[232:235], v[72:75], v[92:95]
    ds_read_b64_tr_b16 v[56:57], v250 offset:40960
    v_mfma_f32_16x16x32_bf16 v[112:115], v[236:239], v[72:75], v[112:115]
    ds_read_b64_tr_b16 v[58:59], v250 offset:42240
    s_cmp_eq_u32 s53, 0
    s_cbranch_scc0 L_rd_89
    s_add_u32 m0, s72, 3072
    s_mov_b32 s61, 983040
    buffer_load_dwordx4 v243, s[68:71], s61 offen  lds
L_rd_89:
    s_waitcnt lgkmcnt(10)
    v_mfma_f32_16x16x32_bf16 v[96:99], v[232:235], v[76:79], v[96:99]
    v_mfma_f32_16x16x32_bf16 v[116:119], v[236:239], v[76:79], v[116:119]
    s_cmp_eq_u32 s53, 0
    s_cbranch_scc0 L_rd_91
    s_add_u32 m0, s72, 4096
    s_mov_b32 s61, 983040
    buffer_load_dwordx4 v244, s[68:71], s61 offen  lds
L_rd_91:
    s_cmp_eq_u32 s48, 0
    s_cbranch_scc0 L_e1b_92
    s_lshr_b32 s54, s82, 2
    s_lshl_b32 s54, s54, 3
    s_and_b32 s55, s82, 3
    s_lshl_b32 s55, s55, 1
    s_add_u32 s54, s54, s55
    s_add_u32 s54, s54, s53
    s_lshl_b32 s54, s54, 6
    s_lshl_b32 s55, s49, 2
    s_add_u32 s54, s54, s55
    s_add_u32 s54, s54, s52
    s_mul_i32 s54, s54, 5120
    s_add_u32 s54, s54, 0
    s_add_u32 s55, s54, 4096
    s_cmp_eq_u32 s53, 0
    s_cbranch_scc0 L_rx_94
    v_cvt_pk_bf16_f32 v120, v80, v81
    v_cvt_pk_bf16_f32 v121, v82, v83
    v_cvt_pk_bf16_f32 v122, v100, v101
    v_cvt_pk_bf16_f32 v123, v102, v103
    buffer_store_dwordx4 v[120:123], v0, s[32:35], s54 offen offset:0 sc1
    v_cvt_pk_bf16_f32 v124, v84, v85
    v_cvt_pk_bf16_f32 v125, v86, v87
    v_cvt_pk_bf16_f32 v126, v104, v105
    v_cvt_pk_bf16_f32 v127, v106, v107
    buffer_store_dwordx4 v[124:127], v0, s[32:35], s54 offen offset:1024 sc1
    v_cvt_pk_bf16_f32 v128, v88, v89
    v_cvt_pk_bf16_f32 v129, v90, v91
    v_cvt_pk_bf16_f32 v130, v108, v109
    v_cvt_pk_bf16_f32 v131, v110, v111
    buffer_store_dwordx4 v[128:131], v0, s[32:35], s54 offen offset:2048 sc1
    v_cvt_pk_bf16_f32 v132, v92, v93
    v_cvt_pk_bf16_f32 v133, v94, v95
    v_cvt_pk_bf16_f32 v134, v112, v113
    v_cvt_pk_bf16_f32 v135, v114, v115
    buffer_store_dwordx4 v[132:135], v0, s[32:35], s54 offen offset:3072 sc1
    v_cvt_pk_bf16_f32 v136, v96, v97
    v_cvt_pk_bf16_f32 v137, v98, v99
    v_cvt_pk_bf16_f32 v138, v116, v117
    v_cvt_pk_bf16_f32 v139, v118, v119
    buffer_store_dwordx4 v[136:139], v0, s[32:35], s55 offen offset:0 sc1
    s_branch L_rd_95
L_rx_94:
    v_cvt_pk_bf16_f32 v120, v100, v101
    v_cvt_pk_bf16_f32 v121, v102, v103
    v_cvt_pk_bf16_f32 v122, v80, v81
    v_cvt_pk_bf16_f32 v123, v82, v83
    buffer_store_dwordx4 v[120:123], v0, s[32:35], s54 offen offset:0 sc1
    v_cvt_pk_bf16_f32 v124, v104, v105
    v_cvt_pk_bf16_f32 v125, v106, v107
    v_cvt_pk_bf16_f32 v126, v84, v85
    v_cvt_pk_bf16_f32 v127, v86, v87
    buffer_store_dwordx4 v[124:127], v0, s[32:35], s54 offen offset:1024 sc1
    v_cvt_pk_bf16_f32 v128, v108, v109
    v_cvt_pk_bf16_f32 v129, v110, v111
    v_cvt_pk_bf16_f32 v130, v88, v89
    v_cvt_pk_bf16_f32 v131, v90, v91
    buffer_store_dwordx4 v[128:131], v0, s[32:35], s54 offen offset:2048 sc1
    v_cvt_pk_bf16_f32 v132, v112, v113
    v_cvt_pk_bf16_f32 v133, v114, v115
    v_cvt_pk_bf16_f32 v134, v92, v93
    v_cvt_pk_bf16_f32 v135, v94, v95
    buffer_store_dwordx4 v[132:135], v0, s[32:35], s54 offen offset:3072 sc1
    v_cvt_pk_bf16_f32 v136, v116, v117
    v_cvt_pk_bf16_f32 v137, v118, v119
    v_cvt_pk_bf16_f32 v138, v96, v97
    v_cvt_pk_bf16_f32 v139, v98, v99
    buffer_store_dwordx4 v[136:139], v0, s[32:35], s55 offen offset:0 sc1
L_rd_95:
    s_nop 1
    s_branch L_e1d_93
L_e1b_92:
    s_waitcnt lgkmcnt(0)
    s_nop 7
    v_mov_b32 v40, v96
    v_mov_b32 v41, v97
    v_mov_b32 v42, v98
    v_mov_b32 v43, v99
    v_mov_b32 v44, v116
    v_mov_b32 v45, v117
    v_mov_b32 v46, v118
    v_mov_b32 v47, v119
    s_mov_b32 s58, 0x3fb8aa3b
    s_mov_b32 s59, 0x3fb8aa3b
    s_mov_b32 s66, 0x358637bd
    s_mov_b32 s67, 0x358637bd
    v_pk_mul_f32 v[120:121], v[80:81], s[58:59]
    v_pk_mul_f32 v[122:123], v[82:83], s[58:59]
    v_exp_f32_e64 v120, v120 clamp
    v_exp_f32_e64 v121, v121 clamp
    v_exp_f32_e64 v122, v122 clamp
    v_exp_f32_e64 v123, v123 clamp
    v_max_f32 v80, 0, v80
    v_max_f32 v81, 0, v81
    v_max_f32 v82, 0, v82
    v_max_f32 v83, 0, v83
    v_pk_add_f32 v[80:81], v[80:81], s[66:67]
    v_pk_add_f32 v[82:83], v[82:83], s[66:67]
    v_pk_add_f32 v[80:81], v[80:81], v[120:121]
    v_pk_add_f32 v[82:83], v[82:83], v[122:123]
    v_pk_mul_f32 v[120:121], v[100:101], s[58:59]
    v_pk_mul_f32 v[122:123], v[102:103], s[58:59]
    v_exp_f32_e64 v120, v120 clamp
    v_exp_f32_e64 v121, v121 clamp
    v_exp_f32_e64 v122, v122 clamp
    v_exp_f32_e64 v123, v123 clamp
    v_max_f32 v100, 0, v100
    v_max_f32 v101, 0, v101
    v_max_f32 v102, 0, v102
    v_max_f32 v103, 0, v103
    v_pk_add_f32 v[100:101], v[100:101], s[66:67]
    v_pk_add_f32 v[102:103], v[102:103], s[66:67]
    v_pk_add_f32 v[100:101], v[100:101], v[120:121]
    v_pk_add_f32 v[102:103], v[102:103], v[122:123]
    v_pk_mul_f32 v[120:121], v[84:85], s[58:59]
    v_pk_mul_f32 v[122:123], v[86:87], s[58:59]
    v_exp_f32_e64 v120, v120 clamp
    v_exp_f32_e64 v121, v121 clamp
    v_exp_f32_e64 v122, v122 clamp
    v_exp_f32_e64 v123, v123 clamp
    v_max_f32 v84, 0, v84
    v_max_f32 v85, 0, v85
    v_max_f32 v86, 0, v86
    v_max_f32 v87, 0, v87
    v_pk_add_f32 v[84:85], v[84:85], s[66:67]
    v_pk_add_f32 v[86:87], v[86:87], s[66:67]
    v_pk_add_f32 v[84:85], v[84:85], v[120:121]
    v_pk_add_f32 v[86:87], v[86:87], v[122:123]
    v_pk_mul_f32 v[120:121], v[104:105], s[58:59]
    v_pk_mul_f32 v[122:123], v[106:107], s[58:59]
    v_exp_f32_e64 v120, v120 clamp
    v_exp_f32_e64 v121, v121 clamp
    v_exp_f32_e64 v122, v122 clamp
    v_exp_f32_e64 v123, v123 clamp
    v_max_f32 v104, 0, v104
    v_max_f32 v105, 0, v105
    v_max_f32 v106, 0, v106
    v_max_f32 v107, 0, v107
    v_pk_add_f32 v[104:105], v[104:105], s[66:67]
    v_pk_add_f32 v[106:107], v[106:107], s[66:67]
    v_pk_add_f32 v[104:105], v[104:105], v[120:121]
    v_pk_add_f32 v[106:107], v[106:107], v[122:123]
    v_pk_mul_f32 v[120:121], v[96:97], s[58:59]
    v_pk_mul_f32 v[122:123], v[98:99], s[58:59]
    v_exp_f32_e64 v120, v120 clamp
    v_exp_f32_e64 v121, v121 clamp
    v_exp_f32_e64 v122, v122 clamp
    v_exp_f32_e64 v123, v123 clamp
    v_max_f32 v96, 0, v96
    v_max_f32 v97, 0, v97
    v_max_f32 v98, 0, v98
    v_max_f32 v99, 0, v99
    v_pk_add_f32 v[96:97], v[96:97], s[66:67]
    v_pk_add_f32 v[98:99], v[98:99], s[66:67]
    v_pk_add_f32 v[96:97], v[96:97], v[120:121]
    v_pk_add_f32 v[98:99], v[98:99], v[122:123]
    v_pk_mul_f32 v[120:121], v[116:117], s[58:59]
    v_pk_mul_f32 v[122:123], v[118:119], s[58:59]
    v_exp_f32_e64 v120, v120 clamp
    v_exp_f32_e64 v121, v121 clamp
    v_exp_f32_e64 v122, v122 clamp
    v_exp_f32_e64 v123, v123 clamp
    v_max_f32 v116, 0, v116
    v_max_f32 v117, 0, v117
    v_max_f32 v118, 0, v118
    v_max_f32 v119, 0, v119
    v_pk_add_f32 v[116:117], v[116:117], s[66:67]
    v_pk_add_f32 v[118:119], v[118:119], s[66:67]
    v_pk_add_f32 v[116:117], v[116:117], v[120:121]
    v_pk_add_f32 v[118:119], v[118:119], v[122:123]
    s_mov_b32 s62, 0x00ff00ff
    s_mov_b32 s63, 0x00ff00ff
    v_cndmask_b32_e64 v96, v40, v96, s[62:63]
    v_cndmask_b32_e64 v97, v41, v97, s[62:63]
    v_cndmask_b32_e64 v98, v42, v98, s[62:63]
    v_cndmask_b32_e64 v99, v43, v99, s[62:63]
    v_cndmask_b32_e64 v116, v44, v116, s[62:63]
    v_cndmask_b32_e64 v117, v45, v117, s[62:63]
    v_cndmask_b32_e64 v118, v46, v118, s[62:63]
    v_cndmask_b32_e64 v119, v47, v119, s[62:63]
    v_cvt_pk_bf16_f32 v60, v80, v81
    v_cvt_pk_bf16_f32 v61, v82, v83
    v_cvt_pk_bf16_f32 v62, v100, v101
    v_cvt_pk_bf16_f32 v63, v102, v103
    v_cvt_pk_bf16_f32 v64, v84, v85
    v_cvt_pk_bf16_f32 v65, v86, v87
    v_cvt_pk_bf16_f32 v66, v104, v105
    v_cvt_pk_bf16_f32 v67, v106, v107
    v_cvt_pk_bf16_f32 v68, v88, v89
    v_cvt_pk_bf16_f32 v69, v90, v91
    v_cvt_pk_bf16_f32 v70, v108, v109
    v_cvt_pk_bf16_f32 v71, v110, v111
    v_cvt_pk_bf16_f32 v72, v92, v93
    v_cvt_pk_bf16_f32 v73, v94, v95
    v_cvt_pk_bf16_f32 v74, v112, v113
    v_cvt_pk_bf16_f32 v75, v114, v115
    v_cvt_pk_bf16_f32 v76, v96, v97
    v_cvt_pk_bf16_f32 v77, v98, v99
    v_cvt_pk_bf16_f32 v78, v116, v117
    v_cvt_pk_bf16_f32 v79, v118, v119
    v_mov_b32 v120, 0x3f803f80
    v_cndmask_b32_e64 v48, v76, v120, s[62:63]
    v_cndmask_b32_e64 v49, v77, v120, s[62:63]
    v_cndmask_b32_e64 v50, v78, v120, s[62:63]
    v_cndmask_b32_e64 v51, v79, v120, s[62:63]
    v_mfma_f32_16x16x32_bf16 v[80:83], v[60:63], v[68:71], 0
    v_mfma_f32_16x16x32_bf16 v[84:87], v[64:67], v[72:75], 0
    v_mfma_f32_16x16x32_bf16 v[88:91], v[60:63], v[48:51], 0
    v_mfma_f32_16x16x32_bf16 v[92:95], v[64:67], v[48:51], 0
    v_mfma_f32_16x16x32_bf16 v[96:99], v[76:79], v[68:71], 0
    v_mfma_f32_16x16x32_bf16 v[100:103], v[76:79], v[72:75], 0
    v_mfma_f32_16x16x32_bf16 v[104:107], v[76:79], v[48:51], 0
    s_barrier
    s_nop 7
    ds_write_b128 v136, v[80:83] offset:0
    ds_write_b128 v136, v[84:87] offset:1024
    ds_write_b128 v136, v[88:91] offset:2048
    ds_write_b128 v136, v[92:95] offset:3072
    ds_write_b128 v136, v[96:99] offset:4096
    ds_write_b128 v136, v[100:103] offset:5120
    ds_write_b128 v136, v[104:107] offset:6144
    s_waitcnt lgkmcnt(0)
    s_barrier
    ds_read_b128 v[80:83], v137 offset:0
    ds_read_b128 v[84:87], v137 offset:7168
    ds_read_b128 v[88:91], v137 offset:14336
    ds_read_b128 v[92:95], v137 offset:21504
    s_waitcnt lgkmcnt(0)
    v_pk_add_f32 v[80:81], v[80:81], v[84:85]
    v_pk_add_f32 v[88:89], v[88:89], v[92:93]
    v_pk_add_f32 v[82:83], v[82:83], v[86:87]
    v_pk_add_f32 v[90:91], v[90:91], v[94:95]
    v_pk_add_f32 v[80:81], v[80:81], v[88:89]
    v_pk_add_f32 v[82:83], v[82:83], v[90:91]
    v_cvt_pk_bf16_f32 v80, v80, v81
    v_cvt_pk_bf16_f32 v81, v82, v83
    s_mov_b64 exec, s[90:91]
    buffer_store_dwordx2 v[80:81], v138, s[32:35], s92 offen sc1
    s_mov_b64 exec, -1
    ds_read_b64_tr_b16 v[40:41], v246 offset:40960
    ds_read_b64_tr_b16 v[42:43], v246 offset:42240
    ds_read_b64_tr_b16 v[44:45], v247 offset:40960
    ds_read_b64_tr_b16 v[46:47], v247 offset:42240
    ds_read_b64_tr_b16 v[48:49], v248 offset:40960
    ds_read_b64_tr_b16 v[50:51], v248 offset:42240
    ds_read_b64_tr_b16 v[52:53], v249 offset:40960
    ds_read_b64_tr_b16 v[54:55], v249 offset:42240
    ds_read_b64_tr_b16 v[56:57], v250 offset:40960
    ds_read_b64_tr_b16 v[58:59], v250 offset:42240
L_e1d_93:
    s_mul_i32 s54, s50, 160
    s_movk_i32 s56, 6554
    s_movk_i32 s57, 1280
    v_add_u32 v4, 0, v1
    v_mul_u32_u24 v8, s56, v4
    v_lshrrev_b32 v8, 16, v8
    v_mul_u32_u24 v9, 10, v8
    v_sub_u32 v9, v4, v9
    v_mul_u32_u24 v8, s57, v8
    v_lshl_add_u32 v8, v9, 4, v8
    v_add_u32 v10, s54, v8
    v_add_u32 v4, 64, v1
    v_mul_u32_u24 v8, s56, v4
    v_lshrrev_b32 v8, 16, v8
    v_mul_u32_u24 v9, 10, v8
    v_sub_u32 v9, v4, v9
    v_mul_u32_u24 v8, s57, v8
    v_lshl_add_u32 v8, v9, 4, v8
    v_add_u32 v11, s54, v8
    v_add_u32 v4, 128, v1
    v_mul_u32_u24 v8, s56, v4
    v_lshrrev_b32 v8, 16, v8
    v_mul_u32_u24 v9, 10, v8
    v_sub_u32 v9, v4, v9
    v_mul_u32_u24 v8, s57, v8
    v_lshl_add_u32 v8, v9, 4, v8
    v_add_u32 v12, s54, v8
    v_add_u32 v4, 192, v1
    v_mul_u32_u24 v8, s56, v4
    v_lshrrev_b32 v8, 16, v8
    v_mul_u32_u24 v9, 10, v8
    v_sub_u32 v9, v4, v9
    v_mul_u32_u24 v8, s57, v8
    v_lshl_add_u32 v8, v9, 4, v8
    v_add_u32 v13, s54, v8
    v_add_u32 v4, 256, v1
    v_mul_u32_u24 v8, s56, v4
    v_lshrrev_b32 v8, 16, v8
    v_mul_u32_u24 v9, 10, v8
    v_sub_u32 v9, v4, v9
    v_mul_u32_u24 v8, s57, v8
    v_lshl_add_u32 v8, v9, 4, v8
    v_add_u32 v14, s54, v8
    s_and_b32 s76, s48, s53
    s_mul_i32 s77, s52, 15360
    s_mul_i32 s79, s52, 122880
    s_waitcnt lgkmcnt(0)
    v_mfma_f32_16x16x32_bf16 v[120:123], v[160:163], v[40:43], 0
    ds_read_b64_tr_b16 v[60:61], v251 offset:40960
    v_mfma_f32_16x16x32_bf16 v[140:143], v[164:167], v[40:43], 0
    ds_read_b64_tr_b16 v[62:63], v251 offset:42240
    v_mfma_f32_16x16x32_bf16 v[124:127], v[160:163], v[44:47], 0
    ds_read_b64_tr_b16 v[64:65], v252 offset:40960
    s_cmp_eq_u32 s76, 0
    s_cbranch_scc1 L_wob_96
    s_add_u32 m0, s77, 0
    s_add_u32 s61, s79, 0
    buffer_load_dwordx4 v10, s[44:47], s61 offen  lds
L_wob_96:
    v_mfma_f32_16x16x32_bf16 v[144:147], v[164:167], v[44:47], 0
    ds_read_b64_tr_b16 v[66:67], v252 offset:42240
    v_mfma_f32_16x16x32_bf16 v[128:131], v[160:163], v[48:51], 0
    ds_read_b64_tr_b16 v[68:69], v253 offset:40960
    v_mfma_f32_16x16x32_bf16 v[148:151], v[164:167], v[48:51], 0
    ds_read_b64_tr_b16 v[70:71], v253 offset:42240
    v_mfma_f32_16x16x32_bf16 v[132:135], v[160:163], v[52:55], 0
    ds_read_b64_tr_b16 v[72:73], v254 offset:40960
    s_cmp_eq_u32 s76, 0
    s_cbranch_scc1 L_wob_97
    s_add_u32 m0, s77, 1024
    s_add_u32 s61, s79, 0
    buffer_load_dwordx4 v11, s[44:47], s61 offen  lds
L_wob_97:
    v_mfma_f32_16x16x32_bf16 v[152:155], v[164:167], v[52:55], 0
    ds_read_b64_tr_b16 v[74:75], v254 offset:42240
    v_mfma_f32_16x16x32_bf16 v[136:139], v[160:163], v[56:59], 0
    ds_read_b64_tr_b16 v[76:77], v255 offset:40960
    v_mfma_f32_16x16x32_bf16 v[156:159], v[164:167], v[56:59], 0
    ds_read_b64_tr_b16 v[78:79], v255 offset:42240
    s_cmp_eq_u32 s53, 0
    s_cbranch_scc0 L_rd_99
    s_cmp_eq_u32 s48, 0
    s_cbranch_scc0 L_wb_100
    s_waitcnt vmcnt(10)
    s_branch L_wd_101
L_wb_100:
    s_waitcnt vmcnt(6)
L_wd_101:
L_rd_99:
    s_barrier
    s_waitcnt lgkmcnt(8)
    v_mfma_f32_16x16x32_bf16 v[120:123], v[168:171], v[60:63], v[120:123]
    ds_read_b64_tr_b16 v[40:41], v246 offset:61440
    v_mfma_f32_16x16x32_bf16 v[140:143], v[172:175], v[60:63], v[140:143]
    ds_read_b64_tr_b16 v[42:43], v246 offset:62720
    s_cmp_eq_u32 s53, 0
    s_cbranch_scc0 L_rd_103
    s_add_u32 m0, s73, 0
    s_mov_b32 s61, 1474560
    buffer_load_dwordx4 v240, s[68:71], s61 offen  lds
L_rd_103:
    s_waitcnt lgkmcnt(8)
    v_mfma_f32_16x16x32_bf16 v[124:127], v[168:171], v[64:67], v[124:127]
    ds_read_b64_tr_b16 v[44:45], v247 offset:61440
    s_cmp_eq_u32 s76, 0
    s_cbranch_scc1 L_wob_104
    s_add_u32 m0, s77, 2048
    s_add_u32 s61, s79, 0
    buffer_load_dwordx4 v12, s[44:47], s61 offen  lds
L_wob_104:
    v_mfma_f32_16x16x32_bf16 v[144:147], v[172:175], v[64:67], v[144:147]
    ds_read_b64_tr_b16 v[46:47], v247 offset:62720
    s_cmp_eq_u32 s53, 0
    s_cbranch_scc0 L_rd_106
    s_add_u32 m0, s73, 1024
    s_mov_b32 s61, 1474560
    buffer_load_dwordx4 v241, s[68:71], s61 offen  lds
L_rd_106:
    s_waitcnt lgkmcnt(8)
    v_mfma_f32_16x16x32_bf16 v[128:131], v[168:171], v[68:71], v[128:131]
    ds_read_b64_tr_b16 v[48:49], v248 offset:61440
    v_mfma_f32_16x16x32_bf16 v[148:151], v[172:175], v[68:71], v[148:151]
    ds_read_b64_tr_b16 v[50:51], v248 offset:62720
    s_cmp_eq_u32 s53, 0
    s_cbranch_scc0 L_rd_108
    s_add_u32 m0, s73, 2048
    s_mov_b32 s61, 1474560
    buffer_load_dwordx4 v242, s[68:71], s61 offen  lds
L_rd_108:
    s_waitcnt lgkmcnt(8)
    v_mfma_f32_16x16x32_bf16 v[132:135], v[168:171], v[72:75], v[132:135]
    ds_read_b64_tr_b16 v[52:53], v249 offset:61440
    v_mfma_f32_16x16x32_bf16 v[152:155], v[172:175], v[72:75], v[152:155]
    ds_read_b64_tr_b16 v[54:55], v249 offset:62720
    s_cmp_eq_u32 s53, 0
    s_cbranch_scc0 L_rd_110
    s_add_u32 m0, s73, 3072
    s_mov_b32 s61, 1474560
    buffer_load_dwordx4 v243, s[68:71], s61 offen  lds
L_rd_110:
    s_waitcnt lgkmcnt(8)
    v_mfma_f32_16x16x32_bf16 v[136:139], v[168:171], v[76:79], v[136:139]
    ds_read_b64_tr_b16 v[56:57], v250 offset:61440
    v_mfma_f32_16x16x32_bf16 v[156:159], v[172:175], v[76:79], v[156:159]
    ds_read_b64_tr_b16 v[58:59], v250 offset:62720
    s_cmp_eq_u32 s53, 0
    s_cbranch_scc0 L_rd_112
    s_add_u32 m0, s73, 4096
    s_mov_b32 s61, 1474560
    buffer_load_dwordx4 v244, s[68:71], s61 offen  lds
L_rd_112:
    s_waitcnt lgkmcnt(8)
    v_mfma_f32_16x16x32_bf16 v[120:123], v[176:179], v[40:43], v[120:123]
    ds_read_b64_tr_b16 v[60:61], v251 offset:61440
    v_mfma_f32_16x16x32_bf16 v[140:143], v[180:183], v[40:43], v[140:143]
    ds_read_b64_tr_b16 v[62:63], v251 offset:62720
    s_waitcnt lgkmcnt(8)
    v_mfma_f32_16x16x32_bf16 v[124:127], v[176:179], v[44:47], v[124:127]
    ds_read_b64_tr_b16 v[64:65], v252 offset:61440
    s_cmp_eq_u32 s76, 0
    s_cbranch_scc1 L_wob_113
    s_add_u32 m0, s77, 3072
    s_add_u32 s61, s79, 0
    buffer_load_dwordx4 v13, s[44:47], s61 offen  lds
L_wob_113:
    v_mfma_f32_16x16x32_bf16 v[144:147], v[180:183], v[44:47], v[144:147]
    ds_read_b64_tr_b16 v[66:67], v252 offset:62720
    s_waitcnt lgkmcnt(8)
    v_mfma_f32_16x16x32_bf16 v[128:131], v[176:179], v[48:51], v[128:131]
    ds_read_b64_tr_b16 v[68:69], v253 offset:61440
    v_mfma_f32_16x16x32_bf16 v[148:151], v[180:183], v[48:51], v[148:151]
    ds_read_b64_tr_b16 v[70:71], v253 offset:62720
    s_waitcnt lgkmcnt(8)
    v_mfma_f32_16x16x32_bf16 v[132:135], v[176:179], v[52:55], v[132:135]
    ds_read_b64_tr_b16 v[72:73], v254 offset:61440
    s_cmp_eq_u32 s76, 0
    s_cbranch_scc1 L_wob_114
    s_add_u32 m0, s77, 4096
    s_add_u32 s61, s79, 0
    buffer_load_dwordx4 v14, s[44:47], s61 offen  lds
L_wob_114:
    v_mfma_f32_16x16x32_bf16 v[152:155], v[180:183], v[52:55], v[152:155]
    ds_read_b64_tr_b16 v[74:75], v254 offset:62720
    s_waitcnt lgkmcnt(8)
    v_mfma_f32_16x16x32_bf16 v[136:139], v[176:179], v[56:59], v[136:139]
    ds_read_b64_tr_b16 v[76:77], v255 offset:61440
    v_mfma_f32_16x16x32_bf16 v[156:159], v[180:183], v[56:59], v[156:159]
    ds_read_b64_tr_b16 v[78:79], v255 offset:62720
    s_cmp_eq_u32 s53, 0
    s_cbranch_scc0 L_rd_116
    s_cmp_eq_u32 s48, 0
    s_cbranch_scc0 L_wb_117
    s_waitcnt vmcnt(10)
    s_branch L_wd_118
L_wb_117:
    s_waitcnt vmcnt(6)
L_wd_118:
L_rd_116:
    s_barrier
    s_waitcnt lgkmcnt(8)
    v_mfma_f32_16x16x32_bf16 v[120:123], v[184:187], v[60:63], v[120:123]
    ds_read_b64_tr_b16 v[40:41], v246 offset:0
    s_cmp_eq_u32 s53, 0
    s_cbranch_scc0 L_rx_119
    s_waitcnt vmcnt(5)
    s_branch L_rd_120
L_rx_119:
    s_cmp_eq_u32 s48, 0
    s_cbranch_scc0 L_wb_121
    s_waitcnt vmcnt(0)
    s_branch L_wd_122
L_wb_121:
    s_waitcnt vmcnt(5)
L_wd_122:
L_rd_120:
    s_lshl_b32 s54, s50, 4
    s_add_u32 s54, s54, s49
    s_lshl_b32 s54, s54, 5
    s_add_u32 s54, s54, s51
    s_lshl_b32 s54, s54, 2
    s_mul_i32 s55, s48, 16384
    s_add_u32 s54, s54, s55
    s_add_u32 s54, s54, 16781312
    v_mov_b32 v4, s3
    v_mov_b32 v5, 0
    s_mov_b64 exec, 1
    buffer_store_dword v4, v5, s[32:35], s54 offen sc0 sc1
    s_mov_b64 exec, -1
    v_mfma_f32_16x16x32_bf16 v[140:143], v[188:191], v[60:63], v[140:143]
    ds_read_b64_tr_b16 v[42:43], v246 offset:1280
    s_cmp_eq_u32 s53, 0
    s_cbranch_scc0 L_rd_124
    s_add_u32 m0, s74, 0
    s_mov_b32 s61, 1966080
    buffer_load_dwordx4 v240, s[68:71], s61 offen  lds
L_rd_124:
    s_waitcnt lgkmcnt(8)
    v_mfma_f32_16x16x32_bf16 v[124:127], v[184:187], v[64:67], v[124:127]
    ds_read_b64_tr_b16 v[44:45], v247 offset:0
    s_cmp_eq_u32 s76, 0
    s_cbranch_scc1 L_wob_125
    s_add_u32 m0, s77, 5120
    s_add_u32 s61, s79, 40960
    buffer_load_dwordx4 v10, s[44:47], s61 offen  lds
L_wob_125:
    v_mfma_f32_16x16x32_bf16 v[144:147], v[188:191], v[64:67], v[144:147]
    ds_read_b64_tr_b16 v[46:47], v247 offset:1280
    s_cmp_eq_u32 s53, 0
    s_cbranch_scc0 L_rd_127
    s_add_u32 m0, s74, 1024
    s_mov_b32 s61, 1966080
    buffer_load_dwordx4 v241, s[68:71], s61 offen  lds
L_rd_127:
    s_waitcnt lgkmcnt(8)
    v_mfma_f32_16x16x32_bf16 v[128:131], v[184:187], v[68:71], v[128:131]
    ds_read_b64_tr_b16 v[48:49], v248 offset:0
    v_mfma_f32_16x16x32_bf16 v[148:151], v[188:191], v[68:71], v[148:151]
    ds_read_b64_tr_b16 v[50:51], v248 offset:1280
    s_cmp_eq_u32 s53, 0
    s_cbranch_scc0 L_rd_129
    s_add_u32 m0, s74, 2048
    s_mov_b32 s61, 1966080
    buffer_load_dwordx4 v242, s[68:71], s61 offen  lds
L_rd_129:
    s_waitcnt lgkmcnt(8)
    v_mfma_f32_16x16x32_bf16 v[132:135], v[184:187], v[72:75], v[132:135]
    ds_read_b64_tr_b16 v[52:53], v249 offset:0
    v_mfma_f32_16x16x32_bf16 v[152:155], v[188:191], v[72:75], v[152:155]
    ds_read_b64_tr_b16 v[54:55], v249 offset:1280
    s_cmp_eq_u32 s53, 0
    s_cbranch_scc0 L_rd_131
    s_add_u32 m0, s74, 3072
    s_mov_b32 s61, 1966080
    buffer_load_dwordx4 v243, s[68:71], s61 offen  lds
L_rd_131:
    s_waitcnt lgkmcnt(8)
    v_mfma_f32_16x16x32_bf16 v[136:139], v[184:187], v[76:79], v[136:139]
    ds_read_b64_tr_b16 v[56:57], v250 offset:0
    v_mfma_f32_16x16x32_bf16 v[156:159], v[188:191], v[76:79], v[156:159]
    ds_read_b64_tr_b16 v[58:59], v250 offset:1280
    s_cmp_eq_u32 s53, 0
    s_cbranch_scc0 L_rd_133
    s_add_u32 m0, s74, 4096
    s_mov_b32 s61, 1966080
    buffer_load_dwordx4 v244, s[68:71], s61 offen  lds
L_rd_133:
    s_waitcnt lgkmcnt(8)
    v_mfma_f32_16x16x32_bf16 v[120:123], v[192:195], v[40:43], v[120:123]
    ds_read_b64_tr_b16 v[60:61], v251 offset:0
    v_mfma_f32_16x16x32_bf16 v[140:143], v[196:199], v[40:43], v[140:143]
    ds_read_b64_tr_b16 v[62:63], v251 offset:1280
    s_waitcnt lgkmcnt(8)
    v_mfma_f32_16x16x32_bf16 v[124:127], v[192:195], v[44:47], v[124:127]
    ds_read_b64_tr_b16 v[64:65], v252 offset:0
    s_cmp_eq_u32 s76, 0
    s_cbranch_scc1 L_wob_134
    s_add_u32 m0, s77, 6144
    s_add_u32 s61, s79, 40960
    buffer_load_dwordx4 v11, s[44:47], s61 offen  lds
L_wob_134:
    v_mfma_f32_16x16x32_bf16 v[144:147], v[196:199], v[44:47], v[144:147]
    ds_read_b64_tr_b16 v[66:67], v252 offset:1280
    s_waitcnt lgkmcnt(8)
    v_mfma_f32_16x16x32_bf16 v[128:131], v[192:195], v[48:51], v[128:131]
    ds_read_b64_tr_b16 v[68:69], v253 offset:0
    v_mfma_f32_16x16x32_bf16 v[148:151], v[196:199], v[48:51], v[148:151]
    ds_read_b64_tr_b16 v[70:71], v253 offset:1280
    s_waitcnt lgkmcnt(8)
    v_mfma_f32_16x16x32_bf16 v[132:135], v[192:195], v[52:55], v[132:135]
    ds_read_b64_tr_b16 v[72:73], v254 offset:0
    s_cmp_eq_u32 s76, 0
    s_cbranch_scc1 L_wob_135
    s_add_u32 m0, s77, 7168
    s_add_u32 s61, s79, 40960
    buffer_load_dwordx4 v12, s[44:47], s61 offen  lds
L_wob_135:
    v_mfma_f32_16x16x32_bf16 v[152:155], v[196:199], v[52:55], v[152:155]
    ds_read_b64_tr_b16 v[74:75], v254 offset:1280
    s_waitcnt lgkmcnt(8)
    v_mfma_f32_16x16x32_bf16 v[136:139], v[192:195], v[56:59], v[136:139]
    ds_read_b64_tr_b16 v[76:77], v255 offset:0
    v_mfma_f32_16x16x32_bf16 v[156:159], v[196:199], v[56:59], v[156:159]
    ds_read_b64_tr_b16 v[78:79], v255 offset:1280
    s_cmp_eq_u32 s53, 0
    s_cbranch_scc0 L_rd_137
    s_waitcnt vmcnt(5)
L_rd_137:
    s_barrier
    s_waitcnt lgkmcnt(8)
    v_mfma_f32_16x16x32_bf16 v[120:123], v[200:203], v[60:63], v[120:123]
    ds_read_b64_tr_b16 v[40:41], v246 offset:20480
    v_mfma_f32_16x16x32_bf16 v[140:143], v[204:207], v[60:63], v[140:143]
    ds_read_b64_tr_b16 v[42:43], v246 offset:21760
    s_waitcnt lgkmcnt(8)
    v_mfma_f32_16x16x32_bf16 v[124:127], v[200:203], v[64:67], v[124:127]
    ds_read_b64_tr_b16 v[44:45], v247 offset:20480
    s_cmp_eq_u32 s76, 0
    s_cbranch_scc1 L_wob_138
    s_add_u32 m0, s77, 8192
    s_add_u32 s61, s79, 40960
    buffer_load_dwordx4 v13, s[44:47], s61 offen  lds
L_wob_138:
    v_mfma_f32_16x16x32_bf16 v[144:147], v[204:207], v[64:67], v[144:147]
    ds_read_b64_tr_b16 v[46:47], v247 offset:21760
    s_waitcnt lgkmcnt(8)
    v_mfma_f32_16x16x32_bf16 v[128:131], v[200:203], v[68:71], v[128:131]
    ds_read_b64_tr_b16 v[48:49], v248 offset:20480
    v_mfma_f32_16x16x32_bf16 v[148:151], v[204:207], v[68:71], v[148:151]
    ds_read_b64_tr_b16 v[50:51], v248 offset:21760
    s_waitcnt lgkmcnt(8)
    v_mfma_f32_16x16x32_bf16 v[132:135], v[200:203], v[72:75], v[132:135]
    ds_read_b64_tr_b16 v[52:53], v249 offset:20480
    v_mfma_f32_16x16x32_bf16 v[152:155], v[204:207], v[72:75], v[152:155]
    ds_read_b64_tr_b16 v[54:55], v249 offset:21760
    s_waitcnt lgkmcnt(8)
    v_mfma_f32_16x16x32_bf16 v[136:139], v[200:203], v[76:79], v[136:139]
    ds_read_b64_tr_b16 v[56:57], v250 offset:20480
    v_mfma_f32_16x16x32_bf16 v[156:159], v[204:207], v[76:79], v[156:159]
    ds_read_b64_tr_b16 v[58:59], v250 offset:21760
    s_waitcnt lgkmcnt(8)
    v_mfma_f32_16x16x32_bf16 v[120:123], v[208:211], v[40:43], v[120:123]
    ds_read_b64_tr_b16 v[60:61], v251 offset:20480
    v_and_b32 v4, 1, v3
    v_lshrrev_b32 v5, 1, v3
    v_lshrrev_b32 v6, 2, v2
    v_and_b32 v7, 3, v2
    v_mfma_f32_16x16x32_bf16 v[140:143], v[212:215], v[40:43], v[140:143]
    ds_read_b64_tr_b16 v[62:63], v251 offset:21760
    s_and_b32 s54, s51, 3
    s_lshr_b32 s55, s51, 2
    s_mul_i32 s55, s55, 5120
    s_lshl_b32 s56, s54, 10
    s_waitcnt lgkmcnt(8)
    v_mfma_f32_16x16x32_bf16 v[124:127], v[208:211], v[44:47], v[124:127]
    ds_read_b64_tr_b16 v[64:65], v252 offset:20480
    s_cmp_eq_u32 s76, 0
    s_cbranch_scc1 L_wob_139
    s_add_u32 m0, s77, 9216
    s_add_u32 s61, s79, 40960
    buffer_load_dwordx4 v14, s[44:47], s61 offen  lds
L_wob_139:
    v_mfma_f32_16x16x32_bf16 v[144:147], v[212:215], v[44:47], v[144:147]
    ds_read_b64_tr_b16 v[66:67], v252 offset:21760
    s_add_u32 s56, s56, s55
    s_add_u32 s57, s55, 4096
    s_lshl_b32 s58, s54, 2
    v_lshl_add_u32 v8, v5, 3, v6
    v_lshl_add_u32 v9, v7, 2, v8
    s_waitcnt lgkmcnt(8)
    v_mfma_f32_16x16x32_bf16 v[128:131], v[208:211], v[48:51], v[128:131]
    ds_read_b64_tr_b16 v[68:69], v253 offset:20480
    v_and_b32 v9, 15, v9
    v_lshl_add_u32 v9, v7, 4, v9
    v_lshlrev_b32 v9, 4, v9
    v_lshl_add_u32 v9, v4, 3, v9
    v_mfma_f32_16x16x32_bf16 v[148:151], v[212:215], v[48:51], v[148:151]
    ds_read_b64_tr_b16 v[70:71], v253 offset:21760
    s_add_u32 s59, s56, 143360
    v_add_u32 v15, s59, v9
    v_add_u32 v30, 4, v8
    v_lshl_add_u32 v9, v7, 2, v30
    s_waitcnt lgkmcnt(8)
    v_mfma_f32_16x16x32_bf16 v[132:135], v[208:211], v[52:55], v[132:135]
    ds_read_b64_tr_b16 v[72:73], v254 offset:20480
    s_cmp_eq_u32 s76, 0
    s_cbranch_scc1 L_wob_140
    s_add_u32 m0, s77, 10240
    s_add_u32 s61, s79, 81920
    buffer_load_dwordx4 v10, s[44:47], s61 offen  lds
L_wob_140:
    v_mfma_f32_16x16x32_bf16 v[152:155], v[212:215], v[52:55], v[152:155]
    ds_read_b64_tr_b16 v[74:75], v254 offset:21760
    v_and_b32 v9, 15, v9
    v_lshl_add_u32 v9, v7, 4, v9
    v_lshlrev_b32 v9, 4, v9
    v_lshl_add_u32 v9, v4, 3, v9
    s_add_u32 s59, s56, 143360
    s_waitcnt lgkmcnt(8)
    v_mfma_f32_16x16x32_bf16 v[136:139], v[208:211], v[56:59], v[136:139]
    ds_read_b64_tr_b16 v[76:77], v255 offset:20480
    v_add_u32 v16, s59, v9
    v_add_u32 v31, s58, v6
    v_lshl_add_u32 v9, v7, 2, v31
    v_and_b32 v9, 15, v9
    v_mfma_f32_16x16x32_bf16 v[156:159], v[212:215], v[56:59], v[156:159]
    ds_read_b64_tr_b16 v[78:79], v255 offset:21760
    v_lshl_add_u32 v9, v7, 4, v9
    v_lshlrev_b32 v9, 4, v9
    v_lshl_add_u32 v9, v4, 3, v9
    s_add_u32 s59, s57, 143360
    v_add_u32 v17, s59, v9
    s_cmp_eq_u32 s53, 0
    s_cbranch_scc0 L_rd_142
    s_waitcnt vmcnt(0)
L_rd_142:
    s_barrier
    s_waitcnt lgkmcnt(8)
    v_mfma_f32_16x16x32_bf16 v[120:123], v[216:219], v[60:63], v[120:123]
    ds_read_b64_tr_b16 v[40:41], v246 offset:40960
    v_mfma_f32_16x16x32_bf16 v[140:143], v[220:223], v[60:63], v[140:143]
    ds_read_b64_tr_b16 v[42:43], v246 offset:42240
    s_cmp_eq_u32 s48, 0
    s_cbranch_scc0 L_oa_143
    v_and_b32 v28, 1, v7
    v_lshl_add_u32 v28, v4, 1, v28
    v_lshrrev_b32 v29, 1, v7
    v_lshl_add_u32 v9, v28, 2, v8
    v_and_b32 v9, 15, v9
    v_lshl_add_u32 v9, v28, 4, v9
    v_lshlrev_b32 v9, 4, v9
    v_lshl_add_u32 v9, v29, 3, v9
    s_add_u32 s59, s56, 0
    v_add_u32 v10, s59, v9
    v_lshl_add_u32 v9, v28, 2, v30
    v_and_b32 v9, 15, v9
    v_lshl_add_u32 v9, v28, 4, v9
    v_lshlrev_b32 v9, 4, v9
    v_lshl_add_u32 v9, v29, 3, v9
    s_add_u32 s59, s56, 0
    v_add_u32 v11, s59, v9
    v_lshl_add_u32 v9, v28, 2, v31
    v_and_b32 v9, 15, v9
    v_lshl_add_u32 v9, v28, 4, v9
    v_lshlrev_b32 v9, 4, v9
    v_lshl_add_u32 v9, v29, 3, v9
    s_add_u32 s59, s57, 0
    v_add_u32 v12, s59, v9
L_oa_143:
    s_waitcnt lgkmcnt(8)
    v_mfma_f32_16x16x32_bf16 v[124:127], v[216:219], v[64:67], v[124:127]
    ds_read_b64_tr_b16 v[44:45], v247 offset:40960
    s_cmp_eq_u32 s76, 0
    s_cbranch_scc1 L_wob_144
    s_add_u32 m0, s77, 11264
    s_add_u32 s61, s79, 81920
    buffer_load_dwordx4 v11, s[44:47], s61 offen  lds
L_wob_144:
    v_mfma_f32_16x16x32_bf16 v[144:147], v[220:223], v[64:67], v[144:147]
    ds_read_b64_tr_b16 v[46:47], v247 offset:42240
    s_waitcnt lgkmcnt(8)
    v_mfma_f32_16x16x32_bf16 v[128:131], v[216:219], v[68:71], v[128:131]
    ds_read_b64_tr_b16 v[48:49], v248 offset:40960
    v_mfma_f32_16x16x32_bf16 v[148:151], v[220:223], v[68:71], v[148:151]
    ds_read_b64_tr_b16 v[50:51], v248 offset:42240
    s_cmp_eq_u32 s48, 0
    s_cbranch_scc0 L_oa_145
    v_and_b32 v4, 31, v1
    v_lshrrev_b32 v5, 5, v1
    v_cmp_gt_u32_e64 s[62:63], 16, v4
    s_sub_u32 s59, s58, 16
    v_add_u32 v6, s59, v4
    v_and_b32 v6, 15, v6
    v_cndmask_b32_e64 v6, v6, v4, s[62:63]
    v_mov_b32 v7, s57
    v_mov_b32 v8, s56
    v_cndmask_b32_e64 v7, v7, v8, s[62:63]
    v_add_u32 v8, 0, v5
    v_lshl_add_u32 v9, v8, 2, v6
    v_and_b32 v9, 15, v9
    v_lshl_add_u32 v9, v8, 4, v9
    v_lshl_add_u32 v9, v9, 4, v7
    v_add_u32 v13, 65536, v9
    v_add_u32 v8, 2, v5
    v_lshl_add_u32 v9, v8, 2, v6
    v_and_b32 v9, 15, v9
    v_lshl_add_u32 v9, v8, 4, v9
    v_lshl_add_u32 v9, v9, 4, v7
    v_add_u32 v14, 65536, v9
L_oa_145:
    s_waitcnt lgkmcnt(8)
    v_mfma_f32_16x16x32_bf16 v[132:135], v[216:219], v[72:75], v[132:135]
    ds_read_b64_tr_b16 v[52:53], v249 offset:40960
    v_mfma_f32_16x16x32_bf16 v[152:155], v[220:223], v[72:75], v[152:155]
    ds_read_b64_tr_b16 v[54:55], v249 offset:42240
    s_waitcnt lgkmcnt(8)
    v_mfma_f32_16x16x32_bf16 v[136:139], v[216:219], v[76:79], v[136:139]
    ds_read_b64_tr_b16 v[56:57], v250 offset:40960
    v_mfma_f32_16x16x32_bf16 v[156:159], v[220:223], v[76:79], v[156:159]
    ds_read_b64_tr_b16 v[58:59], v250 offset:42240
    s_waitcnt lgkmcnt(8)
    v_mfma_f32_16x16x32_bf16 v[120:123], v[224:227], v[40:43], v[120:123]
    ds_read_b64_tr_b16 v[60:61], v251 offset:40960
    v_and_b32 v4, 31, v1
    v_lshrrev_b32 v5, 5, v1
    s_and_b32 s54, s51, 3
    s_lshl_b32 s55, s50, 2
    s_add_u32 s55, s55, s54
    v_mfma_f32_16x16x32_bf16 v[140:143], v[228:231], v[40:43], v[140:143]
    ds_read_b64_tr_b16 v[62:63], v251 offset:42240
    s_lshl_b32 s56, s49, 3
    s_lshr_b32 s57, s51, 2
    s_lshl_b32 s57, s57, 1
    s_add_u32 s56, s56, s57
    s_mul_i32 s56, s56, 20480
    s_waitcnt lgkmcnt(8)
    v_mfma_f32_16x16x32_bf16 v[124:127], v[224:227], v[44:47], v[124:127]
    ds_read_b64_tr_b16 v[64:65], v252 offset:40960
    s_cmp_eq_u32 s76, 0
    s_cbranch_scc1 L_wob_146
    s_add_u32 m0, s77, 12288
    s_add_u32 s61, s79, 81920
    buffer_load_dwordx4 v12, s[44:47], s61 offen  lds
L_wob_146:
    v_mfma_f32_16x16x32_bf16 v[144:147], v[228:231], v[44:47], v[144:147]
    ds_read_b64_tr_b16 v[66:67], v252 offset:42240
    s_cmp_eq_u32 s51, 1
    s_cbranch_scc0 L_ow_147
    s_cmp_eq_u32 s48, 0
    s_cbranch_scc1 L_wpf_148
    buffer_load_dword v245, v29, s[40:43], 0 offen
    s_mov_b32 s61, 15360
    buffer_load_dword v245, v29, s[40:43], s61 offen
L_wpf_148:
L_ow_147:
    s_waitcnt lgkmcnt(8)
    v_mfma_f32_16x16x32_bf16 v[128:131], v[224:227], v[48:51], v[128:131]
    ds_read_b64_tr_b16 v[68:69], v253 offset:40960
    s_mul_i32 s57, s48, 2621440
    s_add_u32 s56, s56, s57
    s_add_u32 s56, s56, 10485760
    v_lshrrev_b32 v6, 4, v4
    s_movk_i32 s57, 20480
    v_mfma_f32_16x16x32_bf16 v[148:151], v[228:231], v[48:51], v[148:151]
    ds_read_b64_tr_b16 v[70:71], v253 offset:42240
    v_mul_u32_u24 v6, s57, v6
    v_and_b32 v7, 15, v4
    v_lshl_add_u32 v6, v7, 4, v6
    v_add_u32 v6, s56, v6
    s_lshr_b32 s57, s55, 1
    s_waitcnt lgkmcnt(8)
    v_mfma_f32_16x16x32_bf16 v[132:135], v[224:227], v[52:55], v[132:135]
    ds_read_b64_tr_b16 v[72:73], v254 offset:40960
    s_cmp_eq_u32 s76, 0
    s_cbranch_scc1 L_wob_149
    s_add_u32 m0, s77, 13312
    s_add_u32 s61, s79, 81920
    buffer_load_dwordx4 v13, s[44:47], s61 offen  lds
L_wob_149:
    v_mfma_f32_16x16x32_bf16 v[152:155], v[228:231], v[52:55], v[152:155]
    ds_read_b64_tr_b16 v[74:75], v254 offset:42240
    s_lshl_b32 s57, s57, 10
    s_and_b32 s58, s55, 1
    s_lshl_b32 s58, s58, 9
    s_add_u32 s57, s57, s58
    v_lshl_add_u32 v7, v5, 8, v6
    s_waitcnt lgkmcnt(8)
    v_mfma_f32_16x16x32_bf16 v[136:139], v[224:227], v[56:59], v[136:139]
    ds_read_b64_tr_b16 v[76:77], v255 offset:40960
    v_add_u32 v18, s57, v7
    s_lshr_b32 s57, s55, 3
    s_add_u32 s57, s57, 16
    s_lshl_b32 s57, s57, 10
    s_and_b32 s58, s55, 6
    v_mfma_f32_16x16x32_bf16 v[156:159], v[228:231], v[56:59], v[156:159]
    ds_read_b64_tr_b16 v[78:79], v255 offset:42240
    s_lshl_b32 s58, s58, 7
    s_add_u32 s57, s57, s58
    s_and_b32 s58, s55, 1
    s_lshl_b32 s58, s58, 3
    s_add_u32 s57, s57, s58
    v_add_u32 v19, s57, v6
    s_waitcnt lgkmcnt(8)
    v_mfma_f32_16x16x32_bf16 v[120:123], v[232:235], v[60:63], v[120:123]
    v_mfma_f32_16x16x32_bf16 v[140:143], v[236:239], v[60:63], v[140:143]
    s_waitcnt lgkmcnt(6)
    v_mfma_f32_16x16x32_bf16 v[124:127], v[232:235], v[64:67], v[124:127]
    s_cmp_eq_u32 s76, 0
    s_cbranch_scc1 L_wob_150
    s_add_u32 m0, s77, 14336
    s_add_u32 s61, s79, 81920
    buffer_load_dwordx4 v14, s[44:47], s61 offen  lds
L_wob_150:
    v_mfma_f32_16x16x32_bf16 v[144:147], v[236:239], v[64:67], v[144:147]
    s_waitcnt lgkmcnt(4)
    v_mfma_f32_16x16x32_bf16 v[128:131], v[232:235], v[68:71], v[128:131]
    v_mfma_f32_16x16x32_bf16 v[148:151], v[236:239], v[68:71], v[148:151]
    s_waitcnt lgkmcnt(2)
    v_mfma_f32_16x16x32_bf16 v[132:135], v[232:235], v[72:75], v[132:135]
    v_mfma_f32_16x16x32_bf16 v[152:155], v[236:239], v[72:75], v[152:155]
    s_waitcnt lgkmcnt(0)
    v_mfma_f32_16x16x32_bf16 v[136:139], v[232:235], v[76:79], v[136:139]
    v_mfma_f32_16x16x32_bf16 v[156:159], v[236:239], v[76:79], v[156:159]
    s_nop 4
    s_cmp_eq_u32 s48, 0
    s_cbranch_scc0 L_p2b_151
    s_lshl_b32 s54, s50, 6
    s_lshl_b32 s55, s49, 2
    s_add_u32 s54, s54, s55
    s_sub_i32 s54, s54, 8
    s_mul_i32 s54, s54, 5120
    s_lshl_b32 s21, s51, 10
    s_add_u32 s20, s54, s21
    s_lshl_b32 s57, s49, 2
    s_sub_i32 s57, 8, s57
    s_max_i32 s57, s57, 0
    s_mul_i32 s22, s57, 5120
    v_lshlrev_b32 v88, 4, v1
    v_and_b32 v7, 7, v1
    v_lshrrev_b32 v8, 3, v1
    v_and_b32 v9, 3, v8
    v_lshrrev_b32 v8, 2, v8
    v_lshlrev_b32 v8, 12, v8
    v_lshlrev_b32 v9, 7, v9
    v_sub_u32 v8, v8, v9
    v_lshl_add_u32 v7, v7, 2, v8
    s_and_b32 s54, s50, 4
    s_and_b32 s55, s50, 3
    s_lshr_b32 s55, s55, 1
    s_add_u32 s54, s54, s55
    s_lshl_b32 s54, s54, 4
    s_add_u32 s54, s54, s49
    s_lshl_b32 s54, s54, 7
    s_add_u32 s54, s54, 16781312
    v_add_u32 v7, s54, v7
    s_min_u32 s55, s49, 2
    s_lshl_b32 s55, s55, 3
    s_lshl_b32 s55, 0x100, s55
    s_sub_u32 s55, s55, 1
    s_mov_b32 s56, 0
    s_cmp_eq_u32 s51, 0
    s_cbranch_scc0 L_ow_153
    s_mov_b32 exec_lo, s55
    s_mov_b32 exec_hi, s55
    s_mov_b32 s59, 0
L_pp_154:
    buffer_load_dword v6, v7, s[32:35], s56 offen sc1
    s_waitcnt vmcnt(0)
    v_cmp_ne_u32_e64 s[62:63], s3, v6
    s_add_u32 s59, s59, 1
    s_nop 1
    s_cmp_eq_u64 s[62:63], 0
    s_cbranch_scc1 L_pd_155
    s_sleep 1
    s_cmp_lt_u32 s59, 40000
    s_cbranch_scc1 L_pp_154
L_pd_155:
    s_mov_b64 exec, -1
L_ow_153:
    s_branch L_p2d_152
L_p2b_151:
    s_and_b32 s54, s51, 1
    s_lshl_b32 s54, s54, 6
    v_add_u32 v5, s54, v1
    s_movk_i32 s55, 2731
    v_mul_u32_u24 v6, s55, v5
    v_lshrrev_b32 v6, 16, v6
    v_mul_u32_u24 v7, 24, v6
    v_sub_u32 v7, v5, v7
    v_cmp_gt_u32_e64 s[62:63], 21, v7
    v_cmp_gt_u32_e64 s[64:65], 5, v6
    s_lshl_b32 s82, s50, 16
    s_lshr_b32 s55, s51, 1
    s_lshl_b32 s55, s55, 10
    s_add_u32 s82, s82, s55
    s_add_u32 s82, s82, 15728640
    v_lshlrev_b32 v88, 3, v5
    s_and_b64 s[80:81], s[62:63], s[64:65]
    v_and_b32 v7, 7, v1
    v_lshrrev_b32 v8, 3, v1
    v_lshlrev_b32 v8, 7, v8
    v_lshl_add_u32 v7, v7, 2, v8
    s_lshl_b32 s54, s50, 11
    s_add_u32 s54, s54, 16797696
    s_cmp_eq_u32 s51, 0
    s_cbranch_scc0 L_ow_156
    s_mov_b32 exec_lo, -1
    s_mov_b32 exec_hi, -1
    s_mov_b32 s59, 0
L_pp_157:
    buffer_load_dword v6, v7, s[32:35], s54 offen sc1
    s_waitcnt vmcnt(0)
    v_cmp_ne_u32_e64 s[62:63], s3, v6
    s_add_u32 s59, s59, 1
    s_nop 1
    s_cmp_eq_u64 s[62:63], 0
    s_cbranch_scc1 L_pd_158
    s_sleep 1
    s_cmp_lt_u32 s59, 40000
    s_cbranch_scc1 L_pp_157
L_pd_158:
    s_mov_b64 exec, -1
L_ow_156:
    s_add_u32 s54, s54, 1024
    s_cmp_eq_u32 s51, 0
    s_cbranch_scc0 L_ow_159
    s_mov_b32 exec_lo, -1
    s_mov_b32 exec_hi, -1
    s_mov_b32 s59, 0
L_pp_160:
    buffer_load_dword v6, v7, s[32:35], s54 offen sc1
    s_waitcnt vmcnt(0)
    v_cmp_ne_u32_e64 s[62:63], s3, v6
    s_add_u32 s59, s59, 1
    s_nop 1
    s_cmp_eq_u64 s[62:63], 0
    s_cbranch_scc1 L_pd_161
    s_sleep 1
    s_cmp_lt_u32 s59, 40000
    s_cbranch_scc1 L_pp_160
L_pd_161:
    s_mov_b64 exec, -1
L_ow_159:
L_p2d_152:
    s_mul_i32 s54, s51, 5120
    s_add_u32 s54, s54, 102400
    v_lshlrev_b32 v4, 4, v1
    s_xor_b32 s55, s51, 4
    v_add_u32 v5, s54, v4
    s_mul_i32 s55, s55, 5120
    s_add_u32 s55, s55, 102400
    s_barrier
    ds_write_b128 v5, v[140:143] offset:0
    ds_write_b128 v5, v[144:147] offset:1024
    ds_write_b128 v5, v[148:151] offset:2048
    ds_write_b128 v5, v[152:155] offset:3072
    ds_write_b128 v5, v[156:159] offset:4096
    s_cmp_eq_u32 s48, 0
    s_cbranch_scc0 L_elb_162
    s_add_u32 s58, s21, 0
    s_add_u32 s61, s20, 0
    s_cmp_lt_u32 s58, s22
    s_cbranch_scc1 L_kvl_164
    s_add_u32 m0, s58, 0
    s_nop 0
    buffer_load_dwordx4 v88, s[32:35], s61 offen sc1 lds
L_kvl_164:
    s_branch L_eld_163
L_elb_162:
    s_mov_b64 exec, s[80:81]
    s_add_u32 s61, s82, 0
    buffer_load_dwordx2 v[160:161], v88, s[32:35], s61 offen sc1
    s_add_u32 s61, s82, 4096
    buffer_load_dwordx2 v[162:163], v88, s[32:35], s61 offen sc1
    s_mov_b64 exec, -1
L_eld_163:
    v_add_u32 v5, s55, v4
    s_lshl_b32 s55, s53, 3
    v_add_u32 v4, s55, v0
    s_mul_i32 s54, s52, 5120
    s_add_u32 s54, s54, 143360
    v_add_u32 v4, s54, v4
    s_waitcnt lgkmcnt(0)
    s_barrier
    ds_read_b128 v[40:43], v5 offset:0
    ds_read_b128 v[44:47], v5 offset:1024
    ds_read_b128 v[48:51], v5 offset:2048
    ds_read_b128 v[52:55], v5 offset:3072
    ds_read_b128 v[56:59], v5 offset:4096
    s_cmp_eq_u32 s48, 0
    s_cbranch_scc0 L_elb_165
    s_add_u32 s58, s21, 8192
    s_add_u32 s61, s20, 8192
    s_cmp_lt_u32 s58, s22
    s_cbranch_scc1 L_kvl_167
    s_add_u32 m0, s58, 0
    s_nop 0
    buffer_load_dwordx4 v88, s[32:35], s61 offen sc1 lds
L_kvl_167:
    s_branch L_eld_166
L_elb_165:
    s_mov_b64 exec, s[80:81]
    s_add_u32 s61, s82, 8192
    buffer_load_dwordx2 v[164:165], v88, s[32:35], s61 offen sc1
    s_add_u32 s61, s82, 12288
    buffer_load_dwordx2 v[166:167], v88, s[32:35], s61 offen sc1
    s_mov_b64 exec, -1
L_eld_166:
    s_waitcnt lgkmcnt(4)
    v_pk_add_f32 v[120:121], v[120:121], v[40:41]
    v_pk_add_f32 v[122:123], v[122:123], v[42:43]
    s_waitcnt lgkmcnt(3)
    v_pk_add_f32 v[124:125], v[124:125], v[44:45]
    v_pk_add_f32 v[126:127], v[126:127], v[46:47]
    s_waitcnt lgkmcnt(2)
    v_pk_add_f32 v[128:129], v[128:129], v[48:49]
    v_pk_add_f32 v[130:131], v[130:131], v[50:51]
    s_waitcnt lgkmcnt(1)
    v_pk_add_f32 v[132:133], v[132:133], v[52:53]
    v_pk_add_f32 v[134:135], v[134:135], v[54:55]
    s_waitcnt lgkmcnt(0)
    v_pk_add_f32 v[136:137], v[136:137], v[56:57]
    v_pk_add_f32 v[138:139], v[138:139], v[58:59]
    s_cmp_eq_u32 s48, 0
    s_cbranch_scc0 L_elb_168
    s_add_u32 s58, s21, 16384
    s_add_u32 s61, s20, 16384
    s_cmp_lt_u32 s58, s22
    s_cbranch_scc1 L_kvl_170
    s_add_u32 m0, s58, 0
    s_nop 0
    buffer_load_dwordx4 v88, s[32:35], s61 offen sc1 lds
L_kvl_170:
    s_branch L_eld_169
L_elb_168:
    s_mov_b64 exec, s[80:81]
    s_add_u32 s61, s82, 16384
    buffer_load_dwordx2 v[168:169], v88, s[32:35], s61 offen sc1
    s_add_u32 s61, s82, 20480
    buffer_load_dwordx2 v[170:171], v88, s[32:35], s61 offen sc1
    s_mov_b64 exec, -1
L_eld_169:
    s_cmp_eq_u32 s48, 0
    s_cbranch_scc0 L_e2b_171
    s_mov_b32 s56, 0x3ea52b5c
    s_mov_b32 s57, 0x3ea52b5c
    v_pk_mul_f32 v[120:121], v[120:121], s[56:57]
    v_pk_mul_f32 v[122:123], v[122:123], s[56:57]
    v_pk_mul_f32 v[124:125], v[124:125], s[56:57]
    v_pk_mul_f32 v[126:127], v[126:127], s[56:57]
    v_pk_mul_f32 v[128:129], v[128:129], s[56:57]
    v_pk_mul_f32 v[130:131], v[130:131], s[56:57]
    v_pk_mul_f32 v[132:133], v[132:133], s[56:57]
    v_pk_mul_f32 v[134:135], v[134:135], s[56:57]
    v_pk_mul_f32 v[136:137], v[136:137], s[56:57]
    v_pk_mul_f32 v[138:139], v[138:139], s[56:57]
    s_branch L_e2d_172
L_e2b_171:
    s_mov_b32 s58, 0x3fb8aa3b
    s_mov_b32 s59, 0x3fb8aa3b
    s_mov_b32 s66, 0x358637bd
    s_mov_b32 s67, 0x358637bd
    v_pk_mul_f32 v[80:81], v[120:121], s[58:59]
    v_pk_mul_f32 v[82:83], v[122:123], s[58:59]
    v_exp_f32_e64 v80, v80 clamp
    v_exp_f32_e64 v81, v81 clamp
    v_exp_f32_e64 v82, v82 clamp
    v_exp_f32_e64 v83, v83 clamp
    v_max_f32 v120, 0, v120
    v_max_f32 v121, 0, v121
    v_max_f32 v122, 0, v122
    v_max_f32 v123, 0, v123
    v_pk_add_f32 v[120:121], v[120:121], s[66:67]
    v_pk_add_f32 v[122:123], v[122:123], s[66:67]
    v_pk_add_f32 v[120:121], v[120:121], v[80:81]
    v_pk_add_f32 v[122:123], v[122:123], v[82:83]
    s_mov_b64 exec, s[80:81]
    s_add_u32 s61, s82, 24576
    buffer_load_dwordx2 v[172:173], v88, s[32:35], s61 offen sc1
    s_add_u32 s61, s82, 28672
    buffer_load_dwordx2 v[174:175], v88, s[32:35], s61 offen sc1
    s_mov_b64 exec, -1
    s_mov_b32 s58, 0x3fb8aa3b
    s_mov_b32 s59, 0x3fb8aa3b
    s_mov_b32 s66, 0x358637bd
    s_mov_b32 s67, 0x358637bd
    v_pk_mul_f32 v[80:81], v[124:125], s[58:59]
    v_pk_mul_f32 v[82:83], v[126:127], s[58:59]
    v_exp_f32_e64 v80, v80 clamp
    v_exp_f32_e64 v81, v81 clamp
    v_exp_f32_e64 v82, v82 clamp
    v_exp_f32_e64 v83, v83 clamp
    v_max_f32 v124, 0, v124
    v_max_f32 v125, 0, v125
    v_max_f32 v126, 0, v126
    v_max_f32 v127, 0, v127
    v_pk_add_f32 v[124:125], v[124:125], s[66:67]
    v_pk_add_f32 v[126:127], v[126:127], s[66:67]
    v_pk_add_f32 v[124:125], v[124:125], v[80:81]
    v_pk_add_f32 v[126:127], v[126:127], v[82:83]
    s_mov_b32 s58, 0x3fb8aa3b
    s_mov_b32 s59, 0x3fb8aa3b
    s_mov_b32 s66, 0x358637bd
    s_mov_b32 s67, 0x358637bd
    v_pk_mul_f32 v[80:81], v[128:129], s[58:59]
    v_pk_mul_f32 v[82:83], v[130:131], s[58:59]
    v_exp_f32_e64 v80, v80 clamp
    v_exp_f32_e64 v81, v81 clamp
    v_exp_f32_e64 v82, v82 clamp
    v_exp_f32_e64 v83, v83 clamp
    v_max_f32 v128, 0, v128
    v_max_f32 v129, 0, v129
    v_max_f32 v130, 0, v130
    v_max_f32 v131, 0, v131
    v_pk_add_f32 v[128:129], v[128:129], s[66:67]
    v_pk_add_f32 v[130:131], v[130:131], s[66:67]
    v_pk_add_f32 v[128:129], v[128:129], v[80:81]
    v_pk_add_f32 v[130:131], v[130:131], v[82:83]
    s_mov_b64 exec, s[80:81]
    s_add_u32 s61, s82, 32768
    buffer_load_dwordx2 v[176:177], v88, s[32:35], s61 offen sc1
    s_add_u32 s61, s82, 36864
    buffer_load_dwordx2 v[178:179], v88, s[32:35], s61 offen sc1
    s_mov_b64 exec, -1
    s_mov_b32 s58, 0x3fb8aa3b
    s_mov_b32 s59, 0x3fb8aa3b
    s_mov_b32 s66, 0x358637bd
    s_mov_b32 s67, 0x358637bd
    v_pk_mul_f32 v[80:81], v[132:133], s[58:59]
    v_pk_mul_f32 v[82:83], v[134:135], s[58:59]
    v_exp_f32_e64 v80, v80 clamp
    v_exp_f32_e64 v81, v81 clamp
    v_exp_f32_e64 v82, v82 clamp
    v_exp_f32_e64 v83, v83 clamp
    v_max_f32 v132, 0, v132
    v_max_f32 v133, 0, v133
    v_max_f32 v134, 0, v134
    v_max_f32 v135, 0, v135
    v_pk_add_f32 v[132:133], v[132:133], s[66:67]
    v_pk_add_f32 v[134:135], v[134:135], s[66:67]
    v_pk_add_f32 v[132:133], v[132:133], v[80:81]
    v_pk_add_f32 v[134:135], v[134:135], v[82:83]
    s_mov_b32 s58, 0x3fb8aa3b
    s_mov_b32 s59, 0x3fb8aa3b
    s_mov_b32 s66, 0x358637bd
    s_mov_b32 s67, 0x358637bd
    v_pk_mul_f32 v[80:81], v[136:137], s[58:59]
    v_pk_mul_f32 v[82:83], v[138:139], s[58:59]
    v_exp_f32_e64 v80, v80 clamp
    v_exp_f32_e64 v81, v81 clamp
    v_exp_f32_e64 v82, v82 clamp
    v_exp_f32_e64 v83, v83 clamp
    v_max_f32 v136, 0, v136
    v_max_f32 v137, 0, v137
    v_max_f32 v138, 0, v138
    v_max_f32 v139, 0, v139
    v_pk_add_f32 v[136:137], v[136:137], s[66:67]
    v_pk_add_f32 v[138:139], v[138:139], s[66:67]
    v_pk_add_f32 v[136:137], v[136:137], v[80:81]
    v_pk_add_f32 v[138:139], v[138:139], v[82:83]
    s_mov_b64 exec, s[80:81]
    s_add_u32 s61, s82, 40960
    buffer_load_dwordx2 v[180:181], v88, s[32:35], s61 offen sc1
    s_add_u32 s61, s82, 45056
    buffer_load_dwordx2 v[182:183], v88, s[32:35], s61 offen sc1
    s_mov_b64 exec, -1
L_e2d_172:
    v_cvt_pk_bf16_f32 v40, v120, v121
    v_cvt_pk_bf16_f32 v41, v122, v123
    ds_write_b64 v4, v[40:41] offset:0
    s_cmp_eq_u32 s48, 0
    s_cbranch_scc0 L_ela_173
    s_add_u32 s58, s21, 24576
    s_add_u32 s61, s20, 24576
    s_cmp_lt_u32 s58, s22
    s_cbranch_scc1 L_kvl_174
    s_add_u32 m0, s58, 0
    s_nop 0
    buffer_load_dwordx4 v88, s[32:35], s61 offen sc1 lds
L_kvl_174:
L_ela_173:
    v_cvt_pk_bf16_f32 v42, v124, v125
    v_cvt_pk_bf16_f32 v43, v126, v127
    ds_write_b64 v4, v[42:43] offset:1024
    v_cvt_pk_bf16_f32 v44, v128, v129
    v_cvt_pk_bf16_f32 v45, v130, v131
    ds_write_b64 v4, v[44:45] offset:2048
    s_cmp_eq_u32 s48, 0
    s_cbranch_scc0 L_ela_175
    s_add_u32 s58, s21, 32768
    s_add_u32 s61, s20, 32768
    s_cmp_lt_u32 s58, s22
    s_cbranch_scc1 L_kvl_176
    s_add_u32 m0, s58, 0
    s_nop 0
    buffer_load_dwordx4 v88, s[32:35], s61 offen sc1 lds
L_kvl_176:
L_ela_175:
    v_cvt_pk_bf16_f32 v46, v132, v133
    v_cvt_pk_bf16_f32 v47, v134, v135
    ds_write_b64 v4, v[46:47] offset:3072
    v_cvt_pk_bf16_f32 v48, v136, v137
    v_cvt_pk_bf16_f32 v49, v138, v139
    ds_write_b64 v4, v[48:49] offset:4096
    s_cmp_eq_u32 s48, 0
    s_cbranch_scc0 L_ela_177
    s_add_u32 s58, s21, 40960
    s_add_u32 s61, s20, 40960
    s_cmp_lt_u32 s58, s22
    s_cbranch_scc1 L_kvl_178
    s_add_u32 m0, s58, 0
    s_nop 0
    buffer_load_dwordx4 v88, s[32:35], s61 offen sc1 lds
L_kvl_178:
L_ela_177:
    s_cmp_eq_u32 s48, 0
    s_cbranch_scc0 L_elb_179
    s_add_u32 s58, s21, 49152
    s_add_u32 s61, s20, 49152
    s_cmp_lt_u32 s58, s22
    s_cbranch_scc1 L_kvl_181
    s_add_u32 m0, s58, 0
    s_nop 0
    buffer_load_dwordx4 v88, s[32:35], s61 offen sc1 lds
L_kvl_181:
    s_branch L_eld_180
L_elb_179:
    s_mov_b64 exec, s[80:81]
    s_add_u32 s61, s82, 49152
    buffer_load_dwordx2 v[184:185], v88, s[32:35], s61 offen sc1
    s_add_u32 s61, s82, 53248
    buffer_load_dwordx2 v[186:187], v88, s[32:35], s61 offen sc1
    s_mov_b64 exec, -1
L_eld_180:
    s_cmp_eq_u32 s48, 0
    s_cbranch_scc0 L_brB_182
    s_add_u32 s58, s21, 57344
    s_cmp_ge_u32 s58, 61440
    s_cbranch_scc1 L_kvl_183
    s_add_u32 s61, s20, 57344
    s_cmp_lt_u32 s58, s22
    s_cbranch_scc1 L_kvl_183
    s_add_u32 m0, s58, 0
    s_nop 0
    buffer_load_dwordx4 v88, s[32:35], s61 offen sc1 lds
L_kvl_183:
    s_mov_b32 s64, 0
    s_mov_b32 s65, -1
    s_mov_b32 s66, -1
    s_mov_b32 s67, 0
    s_mov_b32 s68, 0xffffffff
    s_mov_b32 s69, 0xfffffff0
    s_mov_b32 s70, 0xfffffffe
    s_mov_b32 s71, 0xffffffe0
    s_mov_b32 s72, 0xfffffffc
    s_mov_b32 s73, 0xffffffc0
    s_mov_b32 s74, 0xfffffff8
    s_mov_b32 s75, 0xffffff80
    s_mov_b32 s76, 0xffff0000
    s_mov_b32 s77, 0xfff00000
    s_mov_b32 s78, 0xfffe0000
    s_mov_b32 s79, 0xffe00000
    s_mov_b32 s80, 0xfffc0000
    s_mov_b32 s81, 0xffc00000
    s_mov_b32 s82, 0xfff80000
    s_mov_b32 s83, 0xff800000
    s_mov_b32 s84, 0xffffff00
    s_mov_b32 s85, 0xfffff000
    s_mov_b32 s86, 0xfffffe00
    s_mov_b32 s87, 0xffffe000
    s_mov_b32 s88, 0xfffffc00
    s_mov_b32 s89, 0xffffc000
    s_mov_b32 s90, 0xfffff800
    s_mov_b32 s91, 0xffff8000
    s_mov_b32 s92, 0xff000000
    s_mov_b32 s93, 0xf0000000
    s_mov_b32 s94, 0xfe000000
    s_mov_b32 s95, 0xe0000000
    s_mov_b32 s96, 0xfc000000
    s_mov_b32 s97, 0xc0000000
    s_mov_b32 s98, 0xf8000000
    s_mov_b32 s99, 0x80000000
    v_mov_b32 v30, 0xffff
    v_mov_b32 v31, 0xffff0000
    v_cndmask_b32_e64 v4, 0, v30, s[68:69]
    v_cndmask_b32_e64 v5, 0, v31, s[70:71]
    v_or_b32 v20, v4, v5
    v_cndmask_b32_e64 v4, 0, v30, s[72:73]
    v_cndmask_b32_e64 v5, 0, v31, s[74:75]
    v_or_b32 v21, v4, v5
    v_cndmask_b32_e64 v4, 0, v30, s[76:77]
    v_cndmask_b32_e64 v5, 0, v31, s[78:79]
    v_or_b32 v22, v4, v5
    v_cndmask_b32_e64 v4, 0, v30, s[80:81]
    v_cndmask_b32_e64 v5, 0, v31, s[82:83]
    v_or_b32 v23, v4, v5
    v_cndmask_b32_e64 v4, 0, v30, s[84:85]
    v_cndmask_b32_e64 v5, 0, v31, s[86:87]
    v_or_b32 v24, v4, v5
    v_cndmask_b32_e64 v4, 0, v30, s[88:89]
    v_cndmask_b32_e64 v5, 0, v31, s[90:91]
    v_or_b32 v25, v4, v5
    v_cndmask_b32_e64 v4, 0, v30, s[92:93]
    v_cndmask_b32_e64 v5, 0, v31, s[94:95]
    v_or_b32 v26, v4, v5
    v_cndmask_b32_e64 v4, 0, v30, s[96:97]
    v_cndmask_b32_e64 v5, 0, v31, s[98:99]
    v_or_b32 v27, v4, v5
    v_mov_b32 v4, 0x3f803f80
    v_mov_b32 v64, v4
    v_mov_b32 v65, v4
    v_mov_b32 v66, v4
    v_mov_b32 v67, v4
    v_mov_b32 v68, v4
    v_mov_b32 v69, v4
    v_mov_b32 v70, v4
    v_mov_b32 v71, v4
    v_mov_b32 v72, v4
    v_mov_b32 v73, v4
    v_mov_b32 v74, v4
    v_mov_b32 v75, v4
    v_mov_b32 v76, v4
    v_mov_b32 v77, v4
    v_mov_b32 v78, v4
    v_mov_b32 v79, v4
    v_mov_b32 v80, v4
    v_mov_b32 v81, v4
    v_mov_b32 v82, v4
    v_mov_b32 v83, v4
    v_mov_b32 v84, v4
    v_mov_b32 v85, v4
    v_mov_b32 v86, v4
    v_mov_b32 v87, v4
    v_mov_b32 v46, 0
    v_mov_b32 v47, 0
    v_mov_b32 v54, 0
    v_mov_b32 v55, 0
    v_mov_b32 v62, 0
    v_mov_b32 v63, 0
    v_mov_b32 v38, 0
    v_mov_b32 v39, 0
    s_mov_b32 s62, 0x000fffff
    s_mov_b32 s63, 0x000fffff
    s_waitcnt vmcnt(0) lgkmcnt(0)
    s_barrier
    s_mov_b32 s60, 0
    s_lshl_b32 s54, s49, 2
    s_lshr_b32 s55, s51, 2
    s_add_u32 s54, s54, s55
    s_add_u32 s54, s54, s60
    s_sub_i32 s23, 8, s54
    s_max_i32 s23, s23, 0
    s_cmp_eq_u32 s53, 0
    s_cbranch_scc1 L_prio_184
    s_setprio 1
L_prio_184:
    ds_read_b64_tr_b16 v[32:33], v15
    ds_read_b64_tr_b16 v[34:35], v16
    ds_read_b64_tr_b16 v[36:37], v17
    ds_read_b64_tr_b16 v[40:41], v10 offset:40960
    ds_read_b64_tr_b16 v[42:43], v11 offset:40960
    ds_read_b64_tr_b16 v[44:45], v12 offset:40960
    ds_read_b64_tr_b16 v[48:49], v10 offset:0
    ds_read_b64_tr_b16 v[50:51], v11 offset:0
    ds_read_b64_tr_b16 v[52:53], v12 offset:0
    s_waitcnt lgkmcnt(6)
    v_cndmask_b32_e64 v36, v36, 0, s[64:65]
    v_cndmask_b32_e64 v37, v37, 0, s[64:65]
    ds_read_b64_tr_b16 v[56:57], v10 offset:5120
    ds_read_b64_tr_b16 v[58:59], v11 offset:5120
    ds_read_b64_tr_b16 v[60:61], v12 offset:5120
    s_waitcnt lgkmcnt(6)
    v_mfma_f32_32x32x16_bf16 v[224:239], v[40:43], v[32:35], 0
    v_mfma_f32_32x32x16_bf16 v[224:239], v[44:47], v[36:39], v[224:239]
    s_add_u32 s58, s21, 0
    s_add_u32 s61, s20, 2621440
    s_cmp_lt_u32 s58, s22
    s_cselect_b32 s61, 0x7ff00000, s61
    s_add_u32 m0, s58, 65536
    s_nop 0
    buffer_load_dwordx4 v88, s[32:35], s61 offen sc1 lds
L_kvl_185:
    ds_read_b64_tr_b16 v[40:41], v10 offset:10240
    ds_read_b64_tr_b16 v[42:43], v11 offset:10240
    ds_read_b64_tr_b16 v[44:45], v12 offset:10240
    s_waitcnt lgkmcnt(6)
    s_cmp_gt_u32 s23, 0
    s_cbranch_scc1 L_fill_186
    v_mfma_f32_32x32x16_bf16 v[96:111], v[48:51], v[32:35], 0
L_fret_187:
    s_cmp_gt_u32 s23, 0
    s_cbranch_scc1 L_tl_188
    v_mfma_f32_32x32x16_bf16 v[96:111], v[52:55], v[36:39], v[96:111]
L_tl_188:
    s_add_u32 s58, s21, 8192
    s_add_u32 s61, s20, 2629632
    s_cmp_lt_u32 s58, s22
    s_cselect_b32 s61, 0x7ff00000, s61
    s_add_u32 m0, s58, 65536
    s_nop 0
    buffer_load_dwordx4 v88, s[32:35], s61 offen sc1 lds
L_kvl_189:
    ds_read_b64_tr_b16 v[48:49], v10 offset:15360
    ds_read_b64_tr_b16 v[50:51], v11 offset:15360
    ds_read_b64_tr_b16 v[52:53], v12 offset:15360
    s_waitcnt lgkmcnt(6)
    s_cmp_gt_u32 s23, 1
    s_cbranch_scc1 L_fill_190
    v_mfma_f32_32x32x16_bf16 v[112:127], v[56:59], v[32:35], 0
L_fret_191:
    s_cmp_gt_u32 s23, 1
    s_cbranch_scc1 L_tl_192
    v_mfma_f32_32x32x16_bf16 v[112:127], v[60:63], v[36:39], v[112:127]
L_tl_192:
    s_add_u32 s58, s21, 16384
    s_add_u32 s61, s20, 2637824
    s_cmp_lt_u32 s58, s22
    s_cselect_b32 s61, 0x7ff00000, s61
    s_add_u32 m0, s58, 65536
    s_nop 0
    buffer_load_dwordx4 v88, s[32:35], s61 offen sc1 lds
L_kvl_193:
    ds_read_b64_tr_b16 v[56:57], v10 offset:20480
    ds_read_b64_tr_b16 v[58:59], v11 offset:20480
    ds_read_b64_tr_b16 v[60:61], v12 offset:20480
    s_waitcnt lgkmcnt(6)
    s_cmp_gt_u32 s23, 2
    s_cbranch_scc1 L_fill_194
    v_mfma_f32_32x32x16_bf16 v[128:143], v[40:43], v[32:35], 0
L_fret_195:
    v_cndmask_b32_e64 v96, v96, v224, s[68:69]
    v_cndmask_b32_e64 v97, v97, v225, s[70:71]
    v_cndmask_b32_e64 v98, v98, v226, s[72:73]
    v_cndmask_b32_e64 v99, v99, v227, s[74:75]
    v_cndmask_b32_e64 v100, v100, v228, s[76:77]
    v_cndmask_b32_e64 v101, v101, v229, s[78:79]
    v_cndmask_b32_e64 v102, v102, v230, s[80:81]
    v_cndmask_b32_e64 v103, v103, v231, s[82:83]
    s_cmp_gt_u32 s23, 2
    s_cbranch_scc1 L_tl_196
    v_mfma_f32_32x32x16_bf16 v[128:143], v[44:47], v[36:39], v[128:143]
L_tl_196:
    s_add_u32 s58, s21, 24576
    s_add_u32 s61, s20, 2646016
    s_cmp_lt_u32 s58, s22
    s_cselect_b32 s61, 0x7ff00000, s61
    s_add_u32 m0, s58, 65536
    s_nop 0
    buffer_load_dwordx4 v88, s[32:35], s61 offen sc1 lds
L_kvl_197:
    v_cndmask_b32_e64 v104, v104, v232, s[84:85]
    v_cndmask_b32_e64 v105, v105, v233, s[86:87]
    v_cndmask_b32_e64 v106, v106, v234, s[88:89]
    v_cndmask_b32_e64 v107, v107, v235, s[90:91]
    v_cndmask_b32_e64 v108, v108, v236, s[92:93]
    v_cndmask_b32_e64 v109, v109, v237, s[94:95]
    v_cndmask_b32_e64 v110, v110, v238, s[96:97]
    v_cndmask_b32_e64 v111, v111, v239, s[98:99]
    ds_read_b64_tr_b16 v[40:41], v10 offset:25600
    ds_read_b64_tr_b16 v[42:43], v11 offset:25600
    ds_read_b64_tr_b16 v[44:45], v12 offset:25600
    s_waitcnt lgkmcnt(6)
    s_cmp_gt_u32 s23, 3
    s_cbranch_scc1 L_fill_198
    v_mfma_f32_32x32x16_bf16 v[144:159], v[48:51], v[32:35], 0
L_fret_199:
    v_max_f32 v28, v96, v97
    v_max_f32 v29, v98, v99
    v_max_f32 v30, v100, v101
    v_max_f32 v31, v102, v103
    s_cmp_gt_u32 s23, 3
    s_cbranch_scc1 L_tl_200
    v_mfma_f32_32x32x16_bf16 v[144:159], v[52:55], v[36:39], v[144:159]
L_tl_200:
    s_add_u32 s58, s21, 32768
    s_add_u32 s61, s20, 2654208
    s_cmp_lt_u32 s58, s22
    s_cselect_b32 s61, 0x7ff00000, s61
    s_add_u32 m0, s58, 65536
    s_nop 0
    buffer_load_dwordx4 v88, s[32:35], s61 offen sc1 lds
L_kvl_201:
    v_max3_f32 v28, v104, v105, v28
    v_max3_f32 v29, v106, v107, v29
    v_max3_f32 v30, v108, v109, v30
    v_max3_f32 v31, v110, v111, v31
    ds_read_b64_tr_b16 v[48:49], v10 offset:30720
    ds_read_b64_tr_b16 v[50:51], v11 offset:30720
    ds_read_b64_tr_b16 v[52:53], v12 offset:30720
    s_waitcnt lgkmcnt(6)
    s_cmp_gt_u32 s23, 4
    s_cbranch_scc1 L_fill_202
    v_mfma_f32_32x32x16_bf16 v[160:175], v[56:59], v[32:35], 0
L_fret_203:
    v_max3_f32 v28, v112, v113, v28
    v_max3_f32 v29, v114, v115, v29
    v_max3_f32 v30, v116, v117, v30
    v_max3_f32 v31, v118, v119, v31
    s_cmp_gt_u32 s23, 4
    s_cbranch_scc1 L_tl_204
    v_mfma_f32_32x32x16_bf16 v[160:175], v[60:63], v[36:39], v[160:175]
L_tl_204:
    s_add_u32 s58, s21, 40960
    s_add_u32 s61, s20, 2662400
    s_cmp_lt_u32 s58, s22
    s_cselect_b32 s61, 0x7ff00000, s61
    s_add_u32 m0, s58, 65536
    s_nop 0
    buffer_load_dwordx4 v88, s[32:35], s61 offen sc1 lds
L_kvl_205:
    v_max3_f32 v28, v120, v121, v28
    v_max3_f32 v29, v122, v123, v29
    v_max3_f32 v30, v124, v125, v30
    v_max3_f32 v31, v126, v127, v31
    ds_read_b64_tr_b16 v[56:57], v10 offset:35840
    ds_read_b64_tr_b16 v[58:59], v11 offset:35840
    ds_read_b64_tr_b16 v[60:61], v12 offset:35840
    s_waitcnt lgkmcnt(6)
    s_cmp_gt_u32 s23, 5
    s_cbranch_scc1 L_fill_206
    v_mfma_f32_32x32x16_bf16 v[176:191], v[40:43], v[32:35], 0
L_fret_207:
    v_max3_f32 v28, v128, v129, v28
    v_max3_f32 v29, v130, v131, v29
    v_max3_f32 v30, v132, v133, v30
    v_max3_f32 v31, v134, v135, v31
    s_cmp_gt_u32 s23, 5
    s_cbranch_scc1 L_tl_208
    v_mfma_f32_32x32x16_bf16 v[176:191], v[44:47], v[36:39], v[176:191]
L_tl_208:
    s_add_u32 s58, s21, 49152
    s_add_u32 s61, s20, 2670592
    s_cmp_lt_u32 s58, s22
    s_cselect_b32 s61, 0x7ff00000, s61
    s_add_u32 m0, s58, 65536
    s_nop 0
    buffer_load_dwordx4 v88, s[32:35], s61 offen sc1 lds
L_kvl_209:
    v_max3_f32 v28, v136, v137, v28
    v_max3_f32 v29, v138, v139, v29
    v_max3_f32 v30, v140, v141, v30
    v_max3_f32 v31, v142, v143, v31
    s_waitcnt lgkmcnt(3)
    s_cmp_gt_u32 s23, 6
    s_cbranch_scc1 L_fill_210
    v_mfma_f32_32x32x16_bf16 v[192:207], v[48:51], v[32:35], 0
L_fret_211:
    v_max3_f32 v28, v144, v145, v28
    v_max3_f32 v29, v146, v147, v29
    v_max3_f32 v30, v148, v149, v30
    v_max3_f32 v31, v150, v151, v31
    s_cmp_gt_u32 s23, 6
    s_cbranch_scc1 L_tl_212
    v_mfma_f32_32x32x16_bf16 v[192:207], v[52:55], v[36:39], v[192:207]
L_tl_212:
    s_add_u32 s58, s21, 57344
    s_cmp_ge_u32 s58, 61440
    s_cbranch_scc1 L_kvl_213
    s_add_u32 s61, s20, 2678784
    s_cmp_lt_u32 s58, s22
    s_cselect_b32 s61, 0x7ff00000, s61
    s_add_u32 m0, s58, 65536
    s_nop 0
    buffer_load_dwordx4 v88, s[32:35], s61 offen sc1 lds
L_kvl_213:
    v_max3_f32 v28, v152, v153, v28
    v_max3_f32 v29, v154, v155, v29
    v_max3_f32 v30, v156, v157, v30
    v_max3_f32 v31, v158, v159, v31
    s_waitcnt lgkmcnt(0)
    s_cmp_gt_u32 s23, 7
    s_cbranch_scc1 L_fill_214
    v_mfma_f32_32x32x16_bf16 v[208:223], v[56:59], v[32:35], 0
L_fret_215:
    v_max3_f32 v28, v160, v161, v28
    v_max3_f32 v29, v162, v163, v29
    v_max3_f32 v30, v164, v165, v30
    v_max3_f32 v31, v166, v167, v31
    s_cmp_gt_u32 s23, 7
    s_cbranch_scc1 L_tl_216
    v_mfma_f32_32x32x16_bf16 v[208:223], v[60:63], v[36:39], v[208:223]
L_tl_216:
    v_max3_f32 v28, v168, v169, v28
    v_max3_f32 v29, v170, v171, v29
    v_max3_f32 v30, v172, v173, v30
    v_max3_f32 v31, v174, v175, v31
    v_max3_f32 v28, v176, v177, v28
    v_max3_f32 v29, v178, v179, v29
    v_max3_f32 v30, v180, v181, v30
    v_max3_f32 v31, v182, v183, v31
    v_max3_f32 v28, v184, v185, v28
    v_max3_f32 v29, v186, v187, v29
    v_max3_f32 v30, v188, v189, v30
    v_max3_f32 v31, v190, v191, v31
    v_max3_f32 v28, v192, v193, v28
    v_max3_f32 v29, v194, v195, v29
    v_max3_f32 v30, v196, v197, v30
    v_max3_f32 v31, v198, v199, v31
    v_max3_f32 v28, v200, v201, v28
    v_max3_f32 v29, v202, v203, v29
    v_max3_f32 v30, v204, v205, v30
    v_max3_f32 v31, v206, v207, v31
    v_max3_f32 v28, v208, v209, v28
    v_max3_f32 v29, v210, v211, v29
    v_max3_f32 v30, v212, v213, v30
    v_max3_f32 v31, v214, v215, v31
    v_max3_f32 v28, v216, v217, v28
    v_max3_f32 v29, v218, v219, v29
    v_max3_f32 v30, v220, v221, v30
    v_max3_f32 v31, v222, v223, v31
    v_max3_f32 v28, v28, v29, v30
    v_max_f32 v28, v28, v31
    v_mov_b32 v29, v28
    s_nop 1
    v_permlane32_swap_b32 v28, v29
    s_nop 1
    v_max_f32 v28, v28, v29
    v_pk_add_f32 v[96:97], v[96:97], v[28:29] op_sel_hi:[1,0] neg_lo:[0,1] neg_hi:[0,1]
    v_pk_add_f32 v[98:99], v[98:99], v[28:29] op_sel_hi:[1,0] neg_lo:[0,1] neg_hi:[0,1]
    v_pk_add_f32 v[100:101], v[100:101], v[28:29] op_sel_hi:[1,0] neg_lo:[0,1] neg_hi:[0,1]
    v_pk_add_f32 v[102:103], v[102:103], v[28:29] op_sel_hi:[1,0] neg_lo:[0,1] neg_hi:[0,1]
    v_pk_add_f32 v[104:105], v[104:105], v[28:29] op_sel_hi:[1,0] neg_lo:[0,1] neg_hi:[0,1]
    v_pk_add_f32 v[106:107], v[106:107], v[28:29] op_sel_hi:[1,0] neg_lo:[0,1] neg_hi:[0,1]
    v_pk_add_f32 v[108:109], v[108:109], v[28:29] op_sel_hi:[1,0] neg_lo:[0,1] neg_hi:[0,1]
    v_pk_add_f32 v[110:111], v[110:111], v[28:29] op_sel_hi:[1,0] neg_lo:[0,1] neg_hi:[0,1]
    v_exp_f32 v96, v96
    v_exp_f32 v97, v97
    v_exp_f32 v98, v98
    v_exp_f32 v99, v99
    v_exp_f32 v100, v100
    v_exp_f32 v101, v101
    v_exp_f32 v102, v102
    v_exp_f32 v103, v103
    v_exp_f32 v104, v104
    v_exp_f32 v105, v105
    v_exp_f32 v106, v106
    v_exp_f32 v107, v107
    v_exp_f32 v108, v108
    v_exp_f32 v109, v109
    v_exp_f32 v110, v110
    v_exp_f32 v111, v111
    v_cvt_pk_bf16_f32 v96, v96, v97
    v_cvt_pk_bf16_f32 v97, v98, v99
    v_cvt_pk_bf16_f32 v98, v100, v101
    v_cvt_pk_bf16_f32 v99, v102, v103
    v_cvt_pk_bf16_f32 v100, v104, v105
    v_cvt_pk_bf16_f32 v101, v106, v107
    v_cvt_pk_bf16_f32 v102, v108, v109
    v_cvt_pk_bf16_f32 v103, v110, v111
    s_waitcnt vmcnt(0)
    s_barrier
    s_mov_b64 exec, s[62:63]
    ds_read_b128 v[64:67], v13 offset:40960
    ds_read_b128 v[68:71], v14 offset:40960
    s_mov_b64 exec, -1
    s_mov_b64 exec, s[62:63]
    ds_read_b128 v[72:75], v13 offset:0
    ds_read_b128 v[76:79], v14 offset:0
    s_mov_b64 exec, -1
    v_and_b32 v104, v96, v20
    v_and_b32 v105, v97, v21
    v_and_b32 v106, v98, v22
    v_and_b32 v107, v99, v23
    v_and_b32 v108, v100, v24
    v_and_b32 v109, v101, v25
    v_and_b32 v110, v102, v26
    v_and_b32 v111, v103, v27
    v_xor_b32 v96, v96, v104
    v_xor_b32 v97, v97, v105
    v_xor_b32 v98, v98, v106
    v_xor_b32 v99, v99, v107
    v_xor_b32 v100, v100, v108
    v_xor_b32 v101, v101, v109
    v_xor_b32 v102, v102, v110
    v_xor_b32 v103, v103, v111
    s_waitcnt lgkmcnt(0)
    s_mov_b64 exec, s[62:63]
    ds_read_b128 v[80:83], v13 offset:5120
    ds_read_b128 v[84:87], v14 offset:5120
    s_mov_b64 exec, -1
    v_pk_add_f32 v[112:113], v[112:113], v[28:29] op_sel_hi:[1,0] neg_lo:[0,1] neg_hi:[0,1]
    v_pk_add_f32 v[114:115], v[114:115], v[28:29] op_sel_hi:[1,0] neg_lo:[0,1] neg_hi:[0,1]
    v_pk_add_f32 v[116:117], v[116:117], v[28:29] op_sel_hi:[1,0] neg_lo:[0,1] neg_hi:[0,1]
    v_pk_add_f32 v[118:119], v[118:119], v[28:29] op_sel_hi:[1,0] neg_lo:[0,1] neg_hi:[0,1]
    v_pk_add_f32 v[120:121], v[120:121], v[28:29] op_sel_hi:[1,0] neg_lo:[0,1] neg_hi:[0,1]
    v_pk_add_f32 v[122:123], v[122:123], v[28:29] op_sel_hi:[1,0] neg_lo:[0,1] neg_hi:[0,1]
    v_pk_add_f32 v[124:125], v[124:125], v[28:29] op_sel_hi:[1,0] neg_lo:[0,1] neg_hi:[0,1]
    v_pk_add_f32 v[126:127], v[126:127], v[28:29] op_sel_hi:[1,0] neg_lo:[0,1] neg_hi:[0,1]
    v_exp_f32 v112, v112
    v_mfma_f32_32x32x16_bf16 v[240:255], v[64:67], v[104:107], 0
    v_exp_f32 v113, v113
    v_exp_f32 v114, v114
    v_exp_f32 v115, v115
    v_exp_f32 v116, v116
    v_mfma_f32_32x32x16_bf16 v[240:255], v[68:71], v[108:111], v[240:255]
    v_exp_f32 v117, v117
    v_exp_f32 v118, v118
    v_exp_f32 v119, v119
    v_exp_f32 v120, v120
    v_mfma_f32_32x32x16_bf16 v[240:255], v[72:75], v[96:99], v[240:255]
    v_exp_f32 v121, v121
    v_exp_f32 v122, v122
    v_exp_f32 v123, v123
    v_exp_f32 v124, v124
    v_mfma_f32_32x32x16_bf16 v[240:255], v[76:79], v[100:103], v[240:255]
    v_exp_f32 v125, v125
    v_exp_f32 v126, v126
    v_exp_f32 v127, v127
    v_cvt_pk_bf16_f32 v112, v112, v113
    v_cvt_pk_bf16_f32 v113, v114, v115
    v_cvt_pk_bf16_f32 v114, v116, v117
    v_cvt_pk_bf16_f32 v115, v118, v119
    v_cvt_pk_bf16_f32 v116, v120, v121
    v_cvt_pk_bf16_f32 v117, v122, v123
    v_cvt_pk_bf16_f32 v118, v124, v125
    v_cvt_pk_bf16_f32 v119, v126, v127
    s_waitcnt lgkmcnt(0)
    s_mov_b64 exec, s[62:63]
    ds_read_b128 v[64:67], v13 offset:10240
    ds_read_b128 v[68:71], v14 offset:10240
    s_mov_b64 exec, -1
    v_pk_add_f32 v[128:129], v[128:129], v[28:29] op_sel_hi:[1,0] neg_lo:[0,1] neg_hi:[0,1]
    v_pk_add_f32 v[130:131], v[130:131], v[28:29] op_sel_hi:[1,0] neg_lo:[0,1] neg_hi:[0,1]
    v_pk_add_f32 v[132:133], v[132:133], v[28:29] op_sel_hi:[1,0] neg_lo:[0,1] neg_hi:[0,1]
    v_pk_add_f32 v[134:135], v[134:135], v[28:29] op_sel_hi:[1,0] neg_lo:[0,1] neg_hi:[0,1]
    v_pk_add_f32 v[136:137], v[136:137], v[28:29] op_sel_hi:[1,0] neg_lo:[0,1] neg_hi:[0,1]
    v_pk_add_f32 v[138:139], v[138:139], v[28:29] op_sel_hi:[1,0] neg_lo:[0,1] neg_hi:[0,1]
    v_pk_add_f32 v[140:141], v[140:141], v[28:29] op_sel_hi:[1,0] neg_lo:[0,1] neg_hi:[0,1]
    v_pk_add_f32 v[142:143], v[142:143], v[28:29] op_sel_hi:[1,0] neg_lo:[0,1] neg_hi:[0,1]
    v_exp_f32 v128, v128
    v_exp_f32 v129, v129
    v_mfma_f32_32x32x16_bf16 v[240:255], v[80:83], v[112:115], v[240:255]
    v_exp_f32 v130, v130
    v_exp_f32 v131, v131
    v_exp_f32 v132, v132
    v_exp_f32 v133, v133
    v_exp_f32 v134, v134
    v_exp_f32 v135, v135
    v_exp_f32 v136, v136
    v_exp_f32 v137, v137
    v_mfma_f32_32x32x16_bf16 v[240:255], v[84:87], v[116:119], v[240:255]
    v_exp_f32 v138, v138
    v_exp_f32 v139, v139
    v_exp_f32 v140, v140
    v_exp_f32 v141, v141
    v_exp_f32 v142, v142
    v_exp_f32 v143, v143
    v_cvt_pk_bf16_f32 v128, v128, v129
    v_cvt_pk_bf16_f32 v129, v130, v131
    v_cvt_pk_bf16_f32 v130, v132, v133
    v_cvt_pk_bf16_f32 v131, v134, v135
    v_cvt_pk_bf16_f32 v132, v136, v137
    v_cvt_pk_bf16_f32 v133, v138, v139
    v_cvt_pk_bf16_f32 v134, v140, v141
    v_cvt_pk_bf16_f32 v135, v142, v143
    s_waitcnt lgkmcnt(0)
    s_mov_b64 exec, s[62:63]
    ds_read_b128 v[72:75], v13 offset:15360
    ds_read_b128 v[76:79], v14 offset:15360
    s_mov_b64 exec, -1
    v_pk_add_f32 v[144:145], v[144:145], v[28:29] op_sel_hi:[1,0] neg_lo:[0,1] neg_hi:[0,1]
    v_pk_add_f32 v[146:147], v[146:147], v[28:29] op_sel_hi:[1,0] neg_lo:[0,1] neg_hi:[0,1]
    v_pk_add_f32 v[148:149], v[148:149], v[28:29] op_sel_hi:[1,0] neg_lo:[0,1] neg_hi:[0,1]
    v_pk_add_f32 v[150:151], v[150:151], v[28:29] op_sel_hi:[1,0] neg_lo:[0,1] neg_hi:[0,1]
    v_pk_add_f32 v[152:153], v[152:153], v[28:29] op_sel_hi:[1,0] neg_lo:[0,1] neg_hi:[0,1]
    v_pk_add_f32 v[154:155], v[154:155], v[28:29] op_sel_hi:[1,0] neg_lo:[0,1] neg_hi:[0,1]
    v_pk_add_f32 v[156:157], v[156:157], v[28:29] op_sel_hi:[1,0] neg_lo:[0,1] neg_hi:[0,1]
    v_pk_add_f32 v[158:159], v[158:159], v[28:29] op_sel_hi:[1,0] neg_lo:[0,1] neg_hi:[0,1]
    v_exp_f32 v144, v144
    v_exp_f32 v145, v145
    v_mfma_f32_32x32x16_bf16 v[240:255], v[64:67], v[128:131], v[240:255]
    v_exp_f32 v146, v146
    v_exp_f32 v147, v147
    v_exp_f32 v148, v148
    v_exp_f32 v149, v149
    v_exp_f32 v150, v150
    v_exp_f32 v151, v151
    v_exp_f32 v152, v152
    v_exp_f32 v153, v153
    v_mfma_f32_32x32x16_bf16 v[240:255], v[68:71], v[132:135], v[240:255]
    v_exp_f32 v154, v154
    v_exp_f32 v155, v155
    v_exp_f32 v156, v156
    v_exp_f32 v157, v157
    v_exp_f32 v158, v158
    v_exp_f32 v159, v159
    v_cvt_pk_bf16_f32 v144, v144, v145
    v_cvt_pk_bf16_f32 v145, v146, v147
    v_cvt_pk_bf16_f32 v146, v148, v149
    v_cvt_pk_bf16_f32 v147, v150, v151
    v_cvt_pk_bf16_f32 v148, v152, v153
    v_cvt_pk_bf16_f32 v149, v154, v155
    v_cvt_pk_bf16_f32 v150, v156, v157
    v_cvt_pk_bf16_f32 v151, v158, v159
    s_waitcnt lgkmcnt(0)
    s_mov_b64 exec, s[62:63]
    ds_read_b128 v[80:83], v13 offset:20480
    ds_read_b128 v[84:87], v14 offset:20480
    s_mov_b64 exec, -1
    v_pk_add_f32 v[160:161], v[160:161], v[28:29] op_sel_hi:[1,0] neg_lo:[0,1] neg_hi:[0,1]
    v_pk_add_f32 v[162:163], v[162:163], v[28:29] op_sel_hi:[1,0] neg_lo:[0,1] neg_hi:[0,1]
    v_pk_add_f32 v[164:165], v[164:165], v[28:29] op_sel_hi:[1,0] neg_lo:[0,1] neg_hi:[0,1]
    v_pk_add_f32 v[166:167], v[166:167], v[28:29] op_sel_hi:[1,0] neg_lo:[0,1] neg_hi:[0,1]
    v_pk_add_f32 v[168:169], v[168:169], v[28:29] op_sel_hi:[1,0] neg_lo:[0,1] neg_hi:[0,1]
    v_pk_add_f32 v[170:171], v[170:171], v[28:29] op_sel_hi:[1,0] neg_lo:[0,1] neg_hi:[0,1]
    v_pk_add_f32 v[172:173], v[172:173], v[28:29] op_sel_hi:[1,0] neg_lo:[0,1] neg_hi:[0,1]
    v_pk_add_f32 v[174:175], v[174:175], v[28:29] op_sel_hi:[1,0] neg_lo:[0,1] neg_hi:[0,1]
    v_exp_f32 v160, v160
    v_exp_f32 v161, v161
    v_mfma_f32_32x32x16_bf16 v[240:255], v[72:75], v[144:147], v[240:255]
    v_exp_f32 v162, v162
    v_exp_f32 v163, v163
    v_exp_f32 v164, v164
    v_exp_f32 v165, v165
    v_exp_f32 v166, v166
    v_exp_f32 v167, v167
    v_exp_f32 v168, v168
    v_exp_f32 v169, v169
    v_mfma_f32_32x32x16_bf16 v[240:255], v[76:79], v[148:151], v[240:255]
    v_exp_f32 v170, v170
    v_exp_f32 v171, v171
    v_exp_f32 v172, v172
    v_exp_f32 v173, v173
    v_exp_f32 v174, v174
    v_exp_f32 v175, v175
    v_cvt_pk_bf16_f32 v160, v160, v161
    v_cvt_pk_bf16_f32 v161, v162, v163
    v_cvt_pk_bf16_f32 v162, v164, v165
    v_cvt_pk_bf16_f32 v163, v166, v167
    v_cvt_pk_bf16_f32 v164, v168, v169
    v_cvt_pk_bf16_f32 v165, v170, v171
    v_cvt_pk_bf16_f32 v166, v172, v173
    v_cvt_pk_bf16_f32 v167, v174, v175
    s_waitcnt lgkmcnt(0)
    s_mov_b64 exec, s[62:63]
    ds_read_b128 v[64:67], v13 offset:25600
    ds_read_b128 v[68:71], v14 offset:25600
    s_mov_b64 exec, -1
    v_pk_add_f32 v[176:177], v[176:177], v[28:29] op_sel_hi:[1,0] neg_lo:[0,1] neg_hi:[0,1]
    v_pk_add_f32 v[178:179], v[178:179], v[28:29] op_sel_hi:[1,0] neg_lo:[0,1] neg_hi:[0,1]
    v_pk_add_f32 v[180:181], v[180:181], v[28:29] op_sel_hi:[1,0] neg_lo:[0,1] neg_hi:[0,1]
    v_pk_add_f32 v[182:183], v[182:183], v[28:29] op_sel_hi:[1,0] neg_lo:[0,1] neg_hi:[0,1]
    v_pk_add_f32 v[184:185], v[184:185], v[28:29] op_sel_hi:[1,0] neg_lo:[0,1] neg_hi:[0,1]
    v_pk_add_f32 v[186:187], v[186:187], v[28:29] op_sel_hi:[1,0] neg_lo:[0,1] neg_hi:[0,1]
    v_pk_add_f32 v[188:189], v[188:189], v[28:29] op_sel_hi:[1,0] neg_lo:[0,1] neg_hi:[0,1]
    v_pk_add_f32 v[190:191], v[190:191], v[28:29] op_sel_hi:[1,0] neg_lo:[0,1] neg_hi:[0,1]
    v_exp_f32 v176, v176
    v_exp_f32 v177, v177
    v_mfma_f32_32x32x16_bf16 v[240:255], v[80:83], v[160:163], v[240:255]
    v_exp_f32 v178, v178
    v_exp_f32 v179, v179
    v_exp_f32 v180, v180
    v_exp_f32 v181, v181
    v_exp_f32 v182, v182
    v_exp_f32 v183, v183
    v_exp_f32 v184, v184
    v_exp_f32 v185, v185
    v_mfma_f32_32x32x16_bf16 v[240:255], v[84:87], v[164:167], v[240:255]
    v_exp_f32 v186, v186
    v_exp_f32 v187, v187
    v_exp_f32 v188, v188
    v_exp_f32 v189, v189
    v_exp_f32 v190, v190
    v_exp_f32 v191, v191
    v_cvt_pk_bf16_f32 v176, v176, v177
    v_cvt_pk_bf16_f32 v177, v178, v179
    v_cvt_pk_bf16_f32 v178, v180, v181
    v_cvt_pk_bf16_f32 v179, v182, v183
    v_cvt_pk_bf16_f32 v180, v184, v185
    v_cvt_pk_bf16_f32 v181, v186, v187
    v_cvt_pk_bf16_f32 v182, v188, v189
    v_cvt_pk_bf16_f32 v183, v190, v191
    s_waitcnt lgkmcnt(0)
    s_mov_b64 exec, s[62:63]
    ds_read_b128 v[72:75], v13 offset:30720
    ds_read_b128 v[76:79], v14 offset:30720
    s_mov_b64 exec, -1
    v_pk_add_f32 v[192:193], v[192:193], v[28:29] op_sel_hi:[1,0] neg_lo:[0,1] neg_hi:[0,1]
    v_pk_add_f32 v[194:195], v[194:195], v[28:29] op_sel_hi:[1,0] neg_lo:[0,1] neg_hi:[0,1]
    v_pk_add_f32 v[196:197], v[196:197], v[28:29] op_sel_hi:[1,0] neg_lo:[0,1] neg_hi:[0,1]
    v_pk_add_f32 v[198:199], v[198:199], v[28:29] op_sel_hi:[1,0] neg_lo:[0,1] neg_hi:[0,1]
    v_pk_add_f32 v[200:201], v[200:201], v[28:29] op_sel_hi:[1,0] neg_lo:[0,1] neg_hi:[0,1]
    v_pk_add_f32 v[202:203], v[202:203], v[28:29] op_sel_hi:[1,0] neg_lo:[0,1] neg_hi:[0,1]
    v_pk_add_f32 v[204:205], v[204:205], v[28:29] op_sel_hi:[1,0] neg_lo:[0,1] neg_hi:[0,1]
    v_pk_add_f32 v[206:207], v[206:207], v[28:29] op_sel_hi:[1,0] neg_lo:[0,1] neg_hi:[0,1]
    v_exp_f32 v192, v192
    v_exp_f32 v193, v193
    v_mfma_f32_32x32x16_bf16 v[240:255], v[64:67], v[176:179], v[240:255]
    v_exp_f32 v194, v194
    v_exp_f32 v195, v195
    v_exp_f32 v196, v196
    v_exp_f32 v197, v197
    v_exp_f32 v198, v198
    v_exp_f32 v199, v199
    v_exp_f32 v200, v200
    v_exp_f32 v201, v201
    v_mfma_f32_32x32x16_bf16 v[240:255], v[68:71], v[180:183], v[240:255]
    v_exp_f32 v202, v202
    v_exp_f32 v203, v203
    v_exp_f32 v204, v204
    v_exp_f32 v205, v205
    v_exp_f32 v206, v206
    v_exp_f32 v207, v207
    v_cvt_pk_bf16_f32 v192, v192, v193
    v_cvt_pk_bf16_f32 v193, v194, v195
    v_cvt_pk_bf16_f32 v194, v196, v197
    v_cvt_pk_bf16_f32 v195, v198, v199
    v_cvt_pk_bf16_f32 v196, v200, v201
    v_cvt_pk_bf16_f32 v197, v202, v203
    v_cvt_pk_bf16_f32 v198, v204, v205
    v_cvt_pk_bf16_f32 v199, v206, v207
    s_waitcnt lgkmcnt(0)
    s_mov_b64 exec, s[62:63]
    ds_read_b128 v[80:83], v13 offset:35840
    ds_read_b128 v[84:87], v14 offset:35840
    s_mov_b64 exec, -1
    v_pk_add_f32 v[208:209], v[208:209], v[28:29] op_sel_hi:[1,0] neg_lo:[0,1] neg_hi:[0,1]
    v_pk_add_f32 v[210:211], v[210:211], v[28:29] op_sel_hi:[1,0] neg_lo:[0,1] neg_hi:[0,1]
    v_pk_add_f32 v[212:213], v[212:213], v[28:29] op_sel_hi:[1,0] neg_lo:[0,1] neg_hi:[0,1]
    v_pk_add_f32 v[214:215], v[214:215], v[28:29] op_sel_hi:[1,0] neg_lo:[0,1] neg_hi:[0,1]
    v_pk_add_f32 v[216:217], v[216:217], v[28:29] op_sel_hi:[1,0] neg_lo:[0,1] neg_hi:[0,1]
    v_pk_add_f32 v[218:219], v[218:219], v[28:29] op_sel_hi:[1,0] neg_lo:[0,1] neg_hi:[0,1]
    v_pk_add_f32 v[220:221], v[220:221], v[28:29] op_sel_hi:[1,0] neg_lo:[0,1] neg_hi:[0,1]
    v_pk_add_f32 v[222:223], v[222:223], v[28:29] op_sel_hi:[1,0] neg_lo:[0,1] neg_hi:[0,1]
    v_exp_f32 v208, v208
    v_exp_f32 v209, v209
    v_mfma_f32_32x32x16_bf16 v[240:255], v[72:75], v[192:195], v[240:255]
    v_exp_f32 v210, v210
    v_exp_f32 v211, v211
    v_exp_f32 v212, v212
    v_exp_f32 v213, v213
    v_exp_f32 v214, v214
    v_exp_f32 v215, v215
    v_exp_f32 v216, v216
    v_exp_f32 v217, v217
    v_mfma_f32_32x32x16_bf16 v[240:255], v[76:79], v[196:199], v[240:255]
    v_exp_f32 v218, v218
    v_exp_f32 v219, v219
    v_exp_f32 v220, v220
    v_exp_f32 v221, v221
    v_exp_f32 v222, v222
    v_exp_f32 v223, v223
    v_cvt_pk_bf16_f32 v208, v208, v209
    v_cvt_pk_bf16_f32 v209, v210, v211
    v_cvt_pk_bf16_f32 v210, v212, v213
    v_cvt_pk_bf16_f32 v211, v214, v215
    v_cvt_pk_bf16_f32 v212, v216, v217
    v_cvt_pk_bf16_f32 v213, v218, v219
    v_cvt_pk_bf16_f32 v214, v220, v221
    v_cvt_pk_bf16_f32 v215, v222, v223
    s_waitcnt lgkmcnt(0)
    s_nop 1
    v_mfma_f32_32x32x16_bf16 v[240:255], v[80:83], v[208:211], v[240:255]
    v_mfma_f32_32x32x16_bf16 v[240:255], v[84:87], v[212:215], v[240:255]
    s_nop 15
    v_cndmask_b32_e64 v30, v252, v248, s[64:65]
    v_rcp_f32 v30, v30
    s_nop 0
    v_pk_mul_f32 v[240:241], v[240:241], v[30:31] op_sel_hi:[1,0]
    v_pk_mul_f32 v[242:243], v[242:243], v[30:31] op_sel_hi:[1,0]
    v_pk_mul_f32 v[244:245], v[244:245], v[30:31] op_sel_hi:[1,0]
    v_pk_mul_f32 v[246:247], v[246:247], v[30:31] op_sel_hi:[1,0]
    v_pk_mul_f32 v[248:249], v[248:249], v[30:31] op_sel_hi:[1,0]
    v_pk_mul_f32 v[250:251], v[250:251], v[30:31] op_sel_hi:[1,0]
    v_cvt_pk_bf16_f32 v240, v240, v241
    v_cvt_pk_bf16_f32 v241, v242, v243
    v_cvt_pk_bf16_f32 v242, v244, v245
    v_cvt_pk_bf16_f32 v243, v246, v247
    v_cvt_pk_bf16_f32 v244, v248, v249
    v_cvt_pk_bf16_f32 v245, v250, v251
    buffer_store_dwordx4 v[240:243], v18, s[32:35], 0 offen sc1
    s_mov_b64 exec, s[66:67]
    buffer_store_dwordx2 v[244:245], v19, s[32:35], 0 offen sc1
    s_mov_b64 exec, -1
    v_add_u32 v10, 10240, v10
    v_add_u32 v11, 10240, v11
    v_add_u32 v12, 10240, v12
    v_add_u32 v13, 10240, v13
    v_add_u32 v14, 10240, v14
    v_add_u32 v15, 10240, v15
    v_add_u32 v16, 10240, v16
    v_add_u32 v17, 10240, v17
    v_add_u32 v18, 81920, v18
    v_add_u32 v19, 81920, v19
    s_mov_b32 s60, 2
    s_lshl_b32 s54, s49, 2
    s_lshr_b32 s55, s51, 2
    s_add_u32 s54, s54, s55
    s_add_u32 s54, s54, s60
    s_sub_i32 s23, 8, s54
    s_max_i32 s23, s23, 0
    s_cmp_eq_u32 s53, 0
    s_cbranch_scc1 L_prio_217
    s_setprio 0
L_prio_217:
    ds_read_b64_tr_b16 v[32:33], v15
    ds_read_b64_tr_b16 v[34:35], v16
    ds_read_b64_tr_b16 v[36:37], v17
    ds_read_b64_tr_b16 v[40:41], v10 offset:40960
    ds_read_b64_tr_b16 v[42:43], v11 offset:40960
    ds_read_b64_tr_b16 v[44:45], v12 offset:40960
    ds_read_b64_tr_b16 v[48:49], v10 offset:0
    ds_read_b64_tr_b16 v[50:51], v11 offset:0
    ds_read_b64_tr_b16 v[52:53], v12 offset:0
    s_waitcnt lgkmcnt(6)
    v_cndmask_b32_e64 v36, v36, 0, s[64:65]
    v_cndmask_b32_e64 v37, v37, 0, s[64:65]
    ds_read_b64_tr_b16 v[56:57], v10 offset:5120
    ds_read_b64_tr_b16 v[58:59], v11 offset:5120
    ds_read_b64_tr_b16 v[60:61], v12 offset:5120
    s_waitcnt lgkmcnt(6)
    v_mfma_f32_32x32x16_bf16 v[224:239], v[40:43], v[32:35], 0
    v_mfma_f32_32x32x16_bf16 v[224:239], v[44:47], v[36:39], v[224:239]
    ds_read_b64_tr_b16 v[40:41], v10 offset:10240
    ds_read_b64_tr_b16 v[42:43], v11 offset:10240
    ds_read_b64_tr_b16 v[44:45], v12 offset:10240
    s_waitcnt lgkmcnt(6)
    s_cmp_gt_u32 s23, 0
    s_cbranch_scc1 L_fill_218
    v_mfma_f32_32x32x16_bf16 v[96:111], v[48:51], v[32:35], 0
L_fret_219:
    s_cmp_gt_u32 s23, 0
    s_cbranch_scc1 L_tl_220
    v_mfma_f32_32x32x16_bf16 v[96:111], v[52:55], v[36:39], v[96:111]
L_tl_220:
    ds_read_b64_tr_b16 v[48:49], v10 offset:15360
    ds_read_b64_tr_b16 v[50:51], v11 offset:15360
    ds_read_b64_tr_b16 v[52:53], v12 offset:15360
    s_waitcnt lgkmcnt(6)
    s_cmp_gt_u32 s23, 1
    s_cbranch_scc1 L_fill_221
    v_mfma_f32_32x32x16_bf16 v[112:127], v[56:59], v[32:35], 0
L_fret_222:
    s_cmp_gt_u32 s23, 1
    s_cbranch_scc1 L_tl_223
    v_mfma_f32_32x32x16_bf16 v[112:127], v[60:63], v[36:39], v[112:127]
L_tl_223:
    ds_read_b64_tr_b16 v[56:57], v10 offset:20480
    ds_read_b64_tr_b16 v[58:59], v11 offset:20480
    ds_read_b64_tr_b16 v[60:61], v12 offset:20480
    s_waitcnt lgkmcnt(6)
    s_cmp_gt_u32 s23, 2
    s_cbranch_scc1 L_fill_224
    v_mfma_f32_32x32x16_bf16 v[128:143], v[40:43], v[32:35], 0
L_fret_225:
    v_cndmask_b32_e64 v96, v96, v224, s[68:69]
    v_cndmask_b32_e64 v97, v97, v225, s[70:71]
    v_cndmask_b32_e64 v98, v98, v226, s[72:73]
    v_cndmask_b32_e64 v99, v99, v227, s[74:75]
    v_cndmask_b32_e64 v100, v100, v228, s[76:77]
    v_cndmask_b32_e64 v101, v101, v229, s[78:79]
    v_cndmask_b32_e64 v102, v102, v230, s[80:81]
    v_cndmask_b32_e64 v103, v103, v231, s[82:83]
    s_cmp_gt_u32 s23, 2
    s_cbranch_scc1 L_tl_226
    v_mfma_f32_32x32x16_bf16 v[128:143], v[44:47], v[36:39], v[128:143]
L_tl_226:
    v_cndmask_b32_e64 v104, v104, v232, s[84:85]
    v_cndmask_b32_e64 v105, v105, v233, s[86:87]
    v_cndmask_b32_e64 v106, v106, v234, s[88:89]
    v_cndmask_b32_e64 v107, v107, v235, s[90:91]
    v_cndmask_b32_e64 v108, v108, v236, s[92:93]
    v_cndmask_b32_e64 v109, v109, v237, s[94:95]
    v_cndmask_b32_e64 v110, v110, v238, s[96:97]
    v_cndmask_b32_e64 v111, v111, v239, s[98:99]
    ds_read_b64_tr_b16 v[40:41], v10 offset:25600
    ds_read_b64_tr_b16 v[42:43], v11 offset:25600
    ds_read_b64_tr_b16 v[44:45], v12 offset:25600
    s_waitcnt lgkmcnt(6)
    s_cmp_gt_u32 s23, 3
    s_cbranch_scc1 L_fill_227
    v_mfma_f32_32x32x16_bf16 v[144:159], v[48:51], v[32:35], 0
L_fret_228:
    v_max_f32 v28, v96, v97
    v_max_f32 v29, v98, v99
    v_max_f32 v30, v100, v101
    v_max_f32 v31, v102, v103
    s_cmp_gt_u32 s23, 3
    s_cbranch_scc1 L_tl_229
    v_mfma_f32_32x32x16_bf16 v[144:159], v[52:55], v[36:39], v[144:159]
L_tl_229:
    v_max3_f32 v28, v104, v105, v28
    v_max3_f32 v29, v106, v107, v29
    v_max3_f32 v30, v108, v109, v30
    v_max3_f32 v31, v110, v111, v31
    ds_read_b64_tr_b16 v[48:49], v10 offset:30720
    ds_read_b64_tr_b16 v[50:51], v11 offset:30720
    ds_read_b64_tr_b16 v[52:53], v12 offset:30720
    s_waitcnt lgkmcnt(6)
    s_cmp_gt_u32 s23, 4
    s_cbranch_scc1 L_fill_230
    v_mfma_f32_32x32x16_bf16 v[160:175], v[56:59], v[32:35], 0
L_fret_231:
    v_max3_f32 v28, v112, v113, v28
    v_max3_f32 v29, v114, v115, v29
    v_max3_f32 v30, v116, v117, v30
    v_max3_f32 v31, v118, v119, v31
    s_cmp_gt_u32 s23, 4
    s_cbranch_scc1 L_tl_232
    v_mfma_f32_32x32x16_bf16 v[160:175], v[60:63], v[36:39], v[160:175]
L_tl_232:
    v_max3_f32 v28, v120, v121, v28
    v_max3_f32 v29, v122, v123, v29
    v_max3_f32 v30, v124, v125, v30
    v_max3_f32 v31, v126, v127, v31
    ds_read_b64_tr_b16 v[56:57], v10 offset:35840
    ds_read_b64_tr_b16 v[58:59], v11 offset:35840
    ds_read_b64_tr_b16 v[60:61], v12 offset:35840
    s_waitcnt lgkmcnt(6)
    s_cmp_gt_u32 s23, 5
    s_cbranch_scc1 L_fill_233
    v_mfma_f32_32x32x16_bf16 v[176:191], v[40:43], v[32:35], 0
L_fret_234:
    v_max3_f32 v28, v128, v129, v28
    v_max3_f32 v29, v130, v131, v29
    v_max3_f32 v30, v132, v133, v30
    v_max3_f32 v31, v134, v135, v31
    s_cmp_gt_u32 s23, 5
    s_cbranch_scc1 L_tl_235
    v_mfma_f32_32x32x16_bf16 v[176:191], v[44:47], v[36:39], v[176:191]
L_tl_235:
    s_waitcnt vmcnt(0)
    s_lshl_b32 s54, s49, 1
    s_add_u32 s54, s54, 0
    s_lshl_b32 s54, s54, 3
    s_add_u32 s54, s54, s50
    s_lshl_b32 s54, s54, 5
    s_add_u32 s54, s54, s51
    s_lshl_b32 s54, s54, 2
    s_add_u32 s54, s54, 16814080
    v_mov_b32 v4, s3
    v_mov_b32 v5, 0
    s_mov_b64 exec, 1
    buffer_store_dword v4, v5, s[32:35], s54 offen sc0 sc1
    s_mov_b64 exec, -1
    v_max3_f32 v28, v136, v137, v28
    v_max3_f32 v29, v138, v139, v29
    v_max3_f32 v30, v140, v141, v30
    v_max3_f32 v31, v142, v143, v31
    s_waitcnt lgkmcnt(3)
    s_cmp_gt_u32 s23, 6
    s_cbranch_scc1 L_fill_236
    v_mfma_f32_32x32x16_bf16 v[192:207], v[48:51], v[32:35], 0
L_fret_237:
    v_max3_f32 v28, v144, v145, v28
    v_max3_f32 v29, v146, v147, v29
    v_max3_f32 v30, v148, v149, v30
    v_max3_f32 v31, v150, v151, v31
    s_cmp_gt_u32 s23, 6
    s_cbranch_scc1 L_tl_238
    v_mfma_f32_32x32x16_bf16 v[192:207], v[52:55], v[36:39], v[192:207]
L_tl_238:
    v_max3_f32 v28, v152, v153, v28
    v_max3_f32 v29, v154, v155, v29
    v_max3_f32 v30, v156, v157, v30
    v_max3_f32 v31, v158, v159, v31
    s_waitcnt lgkmcnt(0)
    s_cmp_gt_u32 s23, 7
    s_cbranch_scc1 L_fill_239
    v_mfma_f32_32x32x16_bf16 v[208:223], v[56:59], v[32:35], 0
L_fret_240:
    v_max3_f32 v28, v160, v161, v28
    v_max3_f32 v29, v162, v163, v29
    v_max3_f32 v30, v164, v165, v30
    v_max3_f32 v31, v166, v167, v31
    s_cmp_gt_u32 s23, 7
    s_cbranch_scc1 L_tl_241
    v_mfma_f32_32x32x16_bf16 v[208:223], v[60:63], v[36:39], v[208:223]
L_tl_241:
    v_max3_f32 v28, v168, v169, v28
    v_max3_f32 v29, v170, v171, v29
    v_max3_f32 v30, v172, v173, v30
    v_max3_f32 v31, v174, v175, v31
    v_max3_f32 v28, v176, v177, v28
    v_max3_f32 v29, v178, v179, v29
    v_max3_f32 v30, v180, v181, v30
    v_max3_f32 v31, v182, v183, v31
    v_max3_f32 v28, v184, v185, v28
    v_max3_f32 v29, v186, v187, v29
    v_max3_f32 v30, v188, v189, v30
    v_max3_f32 v31, v190, v191, v31
    v_max3_f32 v28, v192, v193, v28
    v_max3_f32 v29, v194, v195, v29
    v_max3_f32 v30, v196, v197, v30
    v_max3_f32 v31, v198, v199, v31
    v_max3_f32 v28, v200, v201, v28
    v_max3_f32 v29, v202, v203, v29
    v_max3_f32 v30, v204, v205, v30
    v_max3_f32 v31, v206, v207, v31
    s_mov_b64 exec, s[62:63]
    ds_read_b128 v[64:67], v13 offset:40960
    ds_read_b128 v[68:71], v14 offset:40960
    s_mov_b64 exec, -1
    s_mov_b64 exec, s[62:63]
    ds_read_b128 v[72:75], v13 offset:0
    ds_read_b128 v[76:79], v14 offset:0
    s_mov_b64 exec, -1
    v_max3_f32 v28, v208, v209, v28
    v_max3_f32 v29, v210, v211, v29
    v_max3_f32 v30, v212, v213, v30
    v_max3_f32 v31, v214, v215, v31
    v_max3_f32 v28, v216, v217, v28
    v_max3_f32 v29, v218, v219, v29
    v_max3_f32 v30, v220, v221, v30
    v_max3_f32 v31, v222, v223, v31
    v_max3_f32 v28, v28, v29, v30
    v_max_f32 v28, v28, v31
    v_mov_b32 v29, v28
    s_nop 1
    v_permlane32_swap_b32 v28, v29
    s_nop 1
    v_max_f32 v28, v28, v29
    v_pk_add_f32 v[96:97], v[96:97], v[28:29] op_sel_hi:[1,0] neg_lo:[0,1] neg_hi:[0,1]
    v_pk_add_f32 v[98:99], v[98:99], v[28:29] op_sel_hi:[1,0] neg_lo:[0,1] neg_hi:[0,1]
    v_pk_add_f32 v[100:101], v[100:101], v[28:29] op_sel_hi:[1,0] neg_lo:[0,1] neg_hi:[0,1]
    v_pk_add_f32 v[102:103], v[102:103], v[28:29] op_sel_hi:[1,0] neg_lo:[0,1] neg_hi:[0,1]
    v_pk_add_f32 v[104:105], v[104:105], v[28:29] op_sel_hi:[1,0] neg_lo:[0,1] neg_hi:[0,1]
    v_pk_add_f32 v[106:107], v[106:107], v[28:29] op_sel_hi:[1,0] neg_lo:[0,1] neg_hi:[0,1]
    v_pk_add_f32 v[108:109], v[108:109], v[28:29] op_sel_hi:[1,0] neg_lo:[0,1] neg_hi:[0,1]
    v_pk_add_f32 v[110:111], v[110:111], v[28:29] op_sel_hi:[1,0] neg_lo:[0,1] neg_hi:[0,1]
    v_exp_f32 v96, v96
    v_exp_f32 v97, v97
    v_exp_f32 v98, v98
    v_exp_f32 v99, v99
    v_exp_f32 v100, v100
    v_exp_f32 v101, v101
    v_exp_f32 v102, v102
    v_exp_f32 v103, v103
    v_exp_f32 v104, v104
    v_exp_f32 v105, v105
    v_exp_f32 v106, v106
    v_exp_f32 v107, v107
    v_exp_f32 v108, v108
    v_exp_f32 v109, v109
    v_exp_f32 v110, v110
    v_exp_f32 v111, v111
    v_cvt_pk_bf16_f32 v96, v96, v97
    v_cvt_pk_bf16_f32 v97, v98, v99
    v_cvt_pk_bf16_f32 v98, v100, v101
    v_cvt_pk_bf16_f32 v99, v102, v103
    v_cvt_pk_bf16_f32 v100, v104, v105
    v_cvt_pk_bf16_f32 v101, v106, v107
    v_cvt_pk_bf16_f32 v102, v108, v109
    v_cvt_pk_bf16_f32 v103, v110, v111
    v_and_b32 v104, v96, v20
    v_and_b32 v105, v97, v21
    v_and_b32 v106, v98, v22
    v_and_b32 v107, v99, v23
    v_and_b32 v108, v100, v24
    v_and_b32 v109, v101, v25
    v_and_b32 v110, v102, v26
    v_and_b32 v111, v103, v27
    v_xor_b32 v96, v96, v104
    v_xor_b32 v97, v97, v105
    v_xor_b32 v98, v98, v106
    v_xor_b32 v99, v99, v107
    v_xor_b32 v100, v100, v108
    v_xor_b32 v101, v101, v109
    v_xor_b32 v102, v102, v110
    v_xor_b32 v103, v103, v111
    s_waitcnt lgkmcnt(0)
    s_mov_b64 exec, s[62:63]
    ds_read_b128 v[80:83], v13 offset:5120
    ds_read_b128 v[84:87], v14 offset:5120
    s_mov_b64 exec, -1
    v_pk_add_f32 v[112:113], v[112:113], v[28:29] op_sel_hi:[1,0] neg_lo:[0,1] neg_hi:[0,1]
    v_pk_add_f32 v[114:115], v[114:115], v[28:29] op_sel_hi:[1,0] neg_lo:[0,1] neg_hi:[0,1]
    v_pk_add_f32 v[116:117], v[116:117], v[28:29] op_sel_hi:[1,0] neg_lo:[0,1] neg_hi:[0,1]
    v_pk_add_f32 v[118:119], v[118:119], v[28:29] op_sel_hi:[1,0] neg_lo:[0,1] neg_hi:[0,1]
    v_pk_add_f32 v[120:121], v[120:121], v[28:29] op_sel_hi:[1,0] neg_lo:[0,1] neg_hi:[0,1]
    v_pk_add_f32 v[122:123], v[122:123], v[28:29] op_sel_hi:[1,0] neg_lo:[0,1] neg_hi:[0,1]
    v_pk_add_f32 v[124:125], v[124:125], v[28:29] op_sel_hi:[1,0] neg_lo:[0,1] neg_hi:[0,1]
    v_pk_add_f32 v[126:127], v[126:127], v[28:29] op_sel_hi:[1,0] neg_lo:[0,1] neg_hi:[0,1]
    v_exp_f32 v112, v112
    v_mfma_f32_32x32x16_bf16 v[240:255], v[64:67], v[104:107], 0
    v_exp_f32 v113, v113
    v_exp_f32 v114, v114
    v_exp_f32 v115, v115
    v_exp_f32 v116, v116
    v_mfma_f32_32x32x16_bf16 v[240:255], v[68:71], v[108:111], v[240:255]
    v_exp_f32 v117, v117
    v_exp_f32 v118, v118
    v_exp_f32 v119, v119
    v_exp_f32 v120, v120
    v_mfma_f32_32x32x16_bf16 v[240:255], v[72:75], v[96:99], v[240:255]
    v_exp_f32 v121, v121
    v_exp_f32 v122, v122
    v_exp_f32 v123, v123
    v_exp_f32 v124, v124
    v_mfma_f32_32x32x16_bf16 v[240:255], v[76:79], v[100:103], v[240:255]
    v_exp_f32 v125, v125
    v_exp_f32 v126, v126
    v_exp_f32 v127, v127
    v_cvt_pk_bf16_f32 v112, v112, v113
    v_cvt_pk_bf16_f32 v113, v114, v115
    v_cvt_pk_bf16_f32 v114, v116, v117
    v_cvt_pk_bf16_f32 v115, v118, v119
    v_cvt_pk_bf16_f32 v116, v120, v121
    v_cvt_pk_bf16_f32 v117, v122, v123
    v_cvt_pk_bf16_f32 v118, v124, v125
    v_cvt_pk_bf16_f32 v119, v126, v127
    s_waitcnt lgkmcnt(0)
    s_mov_b64 exec, s[62:63]
    ds_read_b128 v[64:67], v13 offset:10240
    ds_read_b128 v[68:71], v14 offset:10240
    s_mov_b64 exec, -1
    v_pk_add_f32 v[128:129], v[128:129], v[28:29] op_sel_hi:[1,0] neg_lo:[0,1] neg_hi:[0,1]
    v_pk_add_f32 v[130:131], v[130:131], v[28:29] op_sel_hi:[1,0] neg_lo:[0,1] neg_hi:[0,1]
    v_pk_add_f32 v[132:133], v[132:133], v[28:29] op_sel_hi:[1,0] neg_lo:[0,1] neg_hi:[0,1]
    v_pk_add_f32 v[134:135], v[134:135], v[28:29] op_sel_hi:[1,0] neg_lo:[0,1] neg_hi:[0,1]
    v_pk_add_f32 v[136:137], v[136:137], v[28:29] op_sel_hi:[1,0] neg_lo:[0,1] neg_hi:[0,1]
    v_pk_add_f32 v[138:139], v[138:139], v[28:29] op_sel_hi:[1,0] neg_lo:[0,1] neg_hi:[0,1]
    v_pk_add_f32 v[140:141], v[140:141], v[28:29] op_sel_hi:[1,0] neg_lo:[0,1] neg_hi:[0,1]
    v_pk_add_f32 v[142:143], v[142:143], v[28:29] op_sel_hi:[1,0] neg_lo:[0,1] neg_hi:[0,1]
    v_exp_f32 v128, v128
    v_exp_f32 v129, v129
    v_mfma_f32_32x32x16_bf16 v[240:255], v[80:83], v[112:115], v[240:255]
    v_exp_f32 v130, v130
    v_exp_f32 v131, v131
    v_exp_f32 v132, v132
    v_exp_f32 v133, v133
    v_exp_f32 v134, v134
    v_exp_f32 v135, v135
    v_exp_f32 v136, v136
    v_exp_f32 v137, v137
    v_mfma_f32_32x32x16_bf16 v[240:255], v[84:87], v[116:119], v[240:255]
    v_exp_f32 v138, v138
    v_exp_f32 v139, v139
    v_exp_f32 v140, v140
    v_exp_f32 v141, v141
    v_exp_f32 v142, v142
    v_exp_f32 v143, v143
    v_cvt_pk_bf16_f32 v128, v128, v129
    v_cvt_pk_bf16_f32 v129, v130, v131
    v_cvt_pk_bf16_f32 v130, v132, v133
    v_cvt_pk_bf16_f32 v131, v134, v135
    v_cvt_pk_bf16_f32 v132, v136, v137
    v_cvt_pk_bf16_f32 v133, v138, v139
    v_cvt_pk_bf16_f32 v134, v140, v141
    v_cvt_pk_bf16_f32 v135, v142, v143
    s_waitcnt lgkmcnt(0)
    s_mov_b64 exec, s[62:63]
    ds_read_b128 v[72:75], v13 offset:15360
    ds_read_b128 v[76:79], v14 offset:15360
    s_mov_b64 exec, -1
    v_pk_add_f32 v[144:145], v[144:145], v[28:29] op_sel_hi:[1,0] neg_lo:[0,1] neg_hi:[0,1]
    v_pk_add_f32 v[146:147], v[146:147], v[28:29] op_sel_hi:[1,0] neg_lo:[0,1] neg_hi:[0,1]
    v_pk_add_f32 v[148:149], v[148:149], v[28:29] op_sel_hi:[1,0] neg_lo:[0,1] neg_hi:[0,1]
    v_pk_add_f32 v[150:151], v[150:151], v[28:29] op_sel_hi:[1,0] neg_lo:[0,1] neg_hi:[0,1]
    v_pk_add_f32 v[152:153], v[152:153], v[28:29] op_sel_hi:[1,0] neg_lo:[0,1] neg_hi:[0,1]
    v_pk_add_f32 v[154:155], v[154:155], v[28:29] op_sel_hi:[1,0] neg_lo:[0,1] neg_hi:[0,1]
    v_pk_add_f32 v[156:157], v[156:157], v[28:29] op_sel_hi:[1,0] neg_lo:[0,1] neg_hi:[0,1]
    v_pk_add_f32 v[158:159], v[158:159], v[28:29] op_sel_hi:[1,0] neg_lo:[0,1] neg_hi:[0,1]
    v_exp_f32 v144, v144
    v_exp_f32 v145, v145
    v_mfma_f32_32x32x16_bf16 v[240:255], v[64:67], v[128:131], v[240:255]
    v_exp_f32 v146, v146
    v_exp_f32 v147, v147
    v_exp_f32 v148, v148
    v_exp_f32 v149, v149
    v_exp_f32 v150, v150
    v_exp_f32 v151, v151
    v_exp_f32 v152, v152
    v_exp_f32 v153, v153
    v_mfma_f32_32x32x16_bf16 v[240:255], v[68:71], v[132:135], v[240:255]
    v_exp_f32 v154, v154
    v_exp_f32 v155, v155
    v_exp_f32 v156, v156
    v_exp_f32 v157, v157
    v_exp_f32 v158, v158
    v_exp_f32 v159, v159
    v_cvt_pk_bf16_f32 v144, v144, v145
    v_cvt_pk_bf16_f32 v145, v146, v147
    v_cvt_pk_bf16_f32 v146, v148, v149
    v_cvt_pk_bf16_f32 v147, v150, v151
    v_cvt_pk_bf16_f32 v148, v152, v153
    v_cvt_pk_bf16_f32 v149, v154, v155
    v_cvt_pk_bf16_f32 v150, v156, v157
    v_cvt_pk_bf16_f32 v151, v158, v159
    s_waitcnt lgkmcnt(0)
    s_mov_b64 exec, s[62:63]
    ds_read_b128 v[80:83], v13 offset:20480
    ds_read_b128 v[84:87], v14 offset:20480
    s_mov_b64 exec, -1
    v_pk_add_f32 v[160:161], v[160:161], v[28:29] op_sel_hi:[1,0] neg_lo:[0,1] neg_hi:[0,1]
    v_pk_add_f32 v[162:163], v[162:163], v[28:29] op_sel_hi:[1,0] neg_lo:[0,1] neg_hi:[0,1]
    v_pk_add_f32 v[164:165], v[164:165], v[28:29] op_sel_hi:[1,0] neg_lo:[0,1] neg_hi:[0,1]
    v_pk_add_f32 v[166:167], v[166:167], v[28:29] op_sel_hi:[1,0] neg_lo:[0,1] neg_hi:[0,1]
    v_pk_add_f32 v[168:169], v[168:169], v[28:29] op_sel_hi:[1,0] neg_lo:[0,1] neg_hi:[0,1]
    v_pk_add_f32 v[170:171], v[170:171], v[28:29] op_sel_hi:[1,0] neg_lo:[0,1] neg_hi:[0,1]
    v_pk_add_f32 v[172:173], v[172:173], v[28:29] op_sel_hi:[1,0] neg_lo:[0,1] neg_hi:[0,1]
    v_pk_add_f32 v[174:175], v[174:175], v[28:29] op_sel_hi:[1,0] neg_lo:[0,1] neg_hi:[0,1]
    v_exp_f32 v160, v160
    v_exp_f32 v161, v161
    v_mfma_f32_32x32x16_bf16 v[240:255], v[72:75], v[144:147], v[240:255]
    v_exp_f32 v162, v162
    v_exp_f32 v163, v163
    v_exp_f32 v164, v164
    v_exp_f32 v165, v165
    v_exp_f32 v166, v166
    v_exp_f32 v167, v167
    v_exp_f32 v168, v168
    v_exp_f32 v169, v169
    v_mfma_f32_32x32x16_bf16 v[240:255], v[76:79], v[148:151], v[240:255]
    v_exp_f32 v170, v170
    v_exp_f32 v171, v171
    v_exp_f32 v172, v172
    v_exp_f32 v173, v173
    v_exp_f32 v174, v174
    v_exp_f32 v175, v175
    v_cvt_pk_bf16_f32 v160, v160, v161
    v_cvt_pk_bf16_f32 v161, v162, v163
    v_cvt_pk_bf16_f32 v162, v164, v165
    v_cvt_pk_bf16_f32 v163, v166, v167
    v_cvt_pk_bf16_f32 v164, v168, v169
    v_cvt_pk_bf16_f32 v165, v170, v171
    v_cvt_pk_bf16_f32 v166, v172, v173
    v_cvt_pk_bf16_f32 v167, v174, v175
    s_waitcnt lgkmcnt(0)
    s_mov_b64 exec, s[62:63]
    ds_read_b128 v[64:67], v13 offset:25600
    ds_read_b128 v[68:71], v14 offset:25600
    s_mov_b64 exec, -1
    v_pk_add_f32 v[176:177], v[176:177], v[28:29] op_sel_hi:[1,0] neg_lo:[0,1] neg_hi:[0,1]
    v_pk_add_f32 v[178:179], v[178:179], v[28:29] op_sel_hi:[1,0] neg_lo:[0,1] neg_hi:[0,1]
    v_pk_add_f32 v[180:181], v[180:181], v[28:29] op_sel_hi:[1,0] neg_lo:[0,1] neg_hi:[0,1]
    v_pk_add_f32 v[182:183], v[182:183], v[28:29] op_sel_hi:[1,0] neg_lo:[0,1] neg_hi:[0,1]
    v_pk_add_f32 v[184:185], v[184:185], v[28:29] op_sel_hi:[1,0] neg_lo:[0,1] neg_hi:[0,1]
    v_pk_add_f32 v[186:187], v[186:187], v[28:29] op_sel_hi:[1,0] neg_lo:[0,1] neg_hi:[0,1]
    v_pk_add_f32 v[188:189], v[188:189], v[28:29] op_sel_hi:[1,0] neg_lo:[0,1] neg_hi:[0,1]
    v_pk_add_f32 v[190:191], v[190:191], v[28:29] op_sel_hi:[1,0] neg_lo:[0,1] neg_hi:[0,1]
    v_exp_f32 v176, v176
    v_exp_f32 v177, v177
    v_mfma_f32_32x32x16_bf16 v[240:255], v[80:83], v[160:163], v[240:255]
    v_exp_f32 v178, v178
    v_exp_f32 v179, v179
    v_exp_f32 v180, v180
    v_exp_f32 v181, v181
    v_exp_f32 v182, v182
    v_exp_f32 v183, v183
    v_exp_f32 v184, v184
    v_exp_f32 v185, v185
    v_mfma_f32_32x32x16_bf16 v[240:255], v[84:87], v[164:167], v[240:255]
    v_exp_f32 v186, v186
    v_exp_f32 v187, v187
    v_exp_f32 v188, v188
    v_exp_f32 v189, v189
    v_exp_f32 v190, v190
    v_exp_f32 v191, v191
    v_cvt_pk_bf16_f32 v176, v176, v177
    v_cvt_pk_bf16_f32 v177, v178, v179
    v_cvt_pk_bf16_f32 v178, v180, v181
    v_cvt_pk_bf16_f32 v179, v182, v183
    v_cvt_pk_bf16_f32 v180, v184, v185
    v_cvt_pk_bf16_f32 v181, v186, v187
    v_cvt_pk_bf16_f32 v182, v188, v189
    v_cvt_pk_bf16_f32 v183, v190, v191
    s_waitcnt lgkmcnt(0)
    s_mov_b64 exec, s[62:63]
    ds_read_b128 v[72:75], v13 offset:30720
    ds_read_b128 v[76:79], v14 offset:30720
    s_mov_b64 exec, -1
    v_pk_add_f32 v[192:193], v[192:193], v[28:29] op_sel_hi:[1,0] neg_lo:[0,1] neg_hi:[0,1]
    v_pk_add_f32 v[194:195], v[194:195], v[28:29] op_sel_hi:[1,0] neg_lo:[0,1] neg_hi:[0,1]
    v_pk_add_f32 v[196:197], v[196:197], v[28:29] op_sel_hi:[1,0] neg_lo:[0,1] neg_hi:[0,1]
    v_pk_add_f32 v[198:199], v[198:199], v[28:29] op_sel_hi:[1,0] neg_lo:[0,1] neg_hi:[0,1]
    v_pk_add_f32 v[200:201], v[200:201], v[28:29] op_sel_hi:[1,0] neg_lo:[0,1] neg_hi:[0,1]
    v_pk_add_f32 v[202:203], v[202:203], v[28:29] op_sel_hi:[1,0] neg_lo:[0,1] neg_hi:[0,1]
    v_pk_add_f32 v[204:205], v[204:205], v[28:29] op_sel_hi:[1,0] neg_lo:[0,1] neg_hi:[0,1]
    v_pk_add_f32 v[206:207], v[206:207], v[28:29] op_sel_hi:[1,0] neg_lo:[0,1] neg_hi:[0,1]
    v_exp_f32 v192, v192
    v_exp_f32 v193, v193
    v_mfma_f32_32x32x16_bf16 v[240:255], v[64:67], v[176:179], v[240:255]
    v_exp_f32 v194, v194
    v_exp_f32 v195, v195
    v_exp_f32 v196, v196
    v_exp_f32 v197, v197
    v_exp_f32 v198, v198
    v_exp_f32 v199, v199
    v_exp_f32 v200, v200
    v_exp_f32 v201, v201
    v_mfma_f32_32x32x16_bf16 v[240:255], v[68:71], v[180:183], v[240:255]
    v_exp_f32 v202, v202
    v_exp_f32 v203, v203
    v_exp_f32 v204, v204
    v_exp_f32 v205, v205
    v_exp_f32 v206, v206
    v_exp_f32 v207, v207
    v_cvt_pk_bf16_f32 v192, v192, v193
    v_cvt_pk_bf16_f32 v193, v194, v195
    v_cvt_pk_bf16_f32 v194, v196, v197
    v_cvt_pk_bf16_f32 v195, v198, v199
    v_cvt_pk_bf16_f32 v196, v200, v201
    v_cvt_pk_bf16_f32 v197, v202, v203
    v_cvt_pk_bf16_f32 v198, v204, v205
    v_cvt_pk_bf16_f32 v199, v206, v207
    s_waitcnt lgkmcnt(0)
    s_mov_b64 exec, s[62:63]
    ds_read_b128 v[80:83], v13 offset:35840
    ds_read_b128 v[84:87], v14 offset:35840
    s_mov_b64 exec, -1
    v_pk_add_f32 v[208:209], v[208:209], v[28:29] op_sel_hi:[1,0] neg_lo:[0,1] neg_hi:[0,1]
    v_pk_add_f32 v[210:211], v[210:211], v[28:29] op_sel_hi:[1,0] neg_lo:[0,1] neg_hi:[0,1]
    v_pk_add_f32 v[212:213], v[212:213], v[28:29] op_sel_hi:[1,0] neg_lo:[0,1] neg_hi:[0,1]
    v_pk_add_f32 v[214:215], v[214:215], v[28:29] op_sel_hi:[1,0] neg_lo:[0,1] neg_hi:[0,1]
    v_pk_add_f32 v[216:217], v[216:217], v[28:29] op_sel_hi:[1,0] neg_lo:[0,1] neg_hi:[0,1]
    v_pk_add_f32 v[218:219], v[218:219], v[28:29] op_sel_hi:[1,0] neg_lo:[0,1] neg_hi:[0,1]
    v_pk_add_f32 v[220:221], v[220:221], v[28:29] op_sel_hi:[1,0] neg_lo:[0,1] neg_hi:[0,1]
    v_pk_add_f32 v[222:223], v[222:223], v[28:29] op_sel_hi:[1,0] neg_lo:[0,1] neg_hi:[0,1]
    v_exp_f32 v208, v208
    v_exp_f32 v209, v209
    v_mfma_f32_32x32x16_bf16 v[240:255], v[72:75], v[192:195], v[240:255]
    v_exp_f32 v210, v210
    v_exp_f32 v211, v211
    v_exp_f32 v212, v212
    v_exp_f32 v213, v213
    v_exp_f32 v214, v214
    v_exp_f32 v215, v215
    v_exp_f32 v216, v216
    v_exp_f32 v217, v217
    v_mfma_f32_32x32x16_bf16 v[240:255], v[76:79], v[196:199], v[240:255]
    v_exp_f32 v218, v218
    v_exp_f32 v219, v219
    v_exp_f32 v220, v220
    v_exp_f32 v221, v221
    v_exp_f32 v222, v222
    v_exp_f32 v223, v223
    v_cvt_pk_bf16_f32 v208, v208, v209
    v_cvt_pk_bf16_f32 v209, v210, v211
    v_cvt_pk_bf16_f32 v210, v212, v213
    v_cvt_pk_bf16_f32 v211, v214, v215
    v_cvt_pk_bf16_f32 v212, v216, v217
    v_cvt_pk_bf16_f32 v213, v218, v219
    v_cvt_pk_bf16_f32 v214, v220, v221
    v_cvt_pk_bf16_f32 v215, v222, v223
    s_waitcnt lgkmcnt(0)
    s_nop 1
    v_mfma_f32_32x32x16_bf16 v[240:255], v[80:83], v[208:211], v[240:255]
    v_mfma_f32_32x32x16_bf16 v[240:255], v[84:87], v[212:215], v[240:255]
    v_lshrrev_b32 v7, 3, v1
    v_and_b32 v8, 7, v1
    v_lshlrev_b32 v7, 7, v7
    v_lshl_add_u32 v7, v8, 2, v7
    s_lshl_b32 s54, s49, 1
    s_add_u32 s54, s54, 0
    s_lshl_b32 s54, s54, 10
    s_add_u32 s54, s54, 16814080
    s_cmp_eq_u32 s51, 0
    s_cbranch_scc0 L_ow_242
    s_mov_b32 exec_lo, -1
    s_mov_b32 exec_hi, -1
    s_mov_b32 s59, 0
L_pp_243:
    buffer_load_dword v6, v7, s[32:35], s54 offen sc1
    s_waitcnt vmcnt(0)
    v_cmp_ne_u32_e64 s[62:63], s3, v6
    s_add_u32 s59, s59, 1
    s_nop 1
    s_cmp_eq_u64 s[62:63], 0
    s_cbranch_scc1 L_pd_244
    s_sleep 1
    s_cmp_lt_u32 s59, 40000
    s_cbranch_scc1 L_pp_243
L_pd_244:
    s_mov_b64 exec, -1
L_ow_242:
    s_nop 15
    v_cndmask_b32_e64 v30, v252, v248, s[64:65]
    v_rcp_f32 v30, v30
    s_nop 0
    v_pk_mul_f32 v[240:241], v[240:241], v[30:31] op_sel_hi:[1,0]
    v_pk_mul_f32 v[242:243], v[242:243], v[30:31] op_sel_hi:[1,0]
    v_pk_mul_f32 v[244:245], v[244:245], v[30:31] op_sel_hi:[1,0]
    v_pk_mul_f32 v[246:247], v[246:247], v[30:31] op_sel_hi:[1,0]
    v_pk_mul_f32 v[248:249], v[248:249], v[30:31] op_sel_hi:[1,0]
    v_pk_mul_f32 v[250:251], v[250:251], v[30:31] op_sel_hi:[1,0]
    v_cvt_pk_bf16_f32 v240, v240, v241
    v_cvt_pk_bf16_f32 v241, v242, v243
    v_cvt_pk_bf16_f32 v242, v244, v245
    v_cvt_pk_bf16_f32 v243, v246, v247
    v_cvt_pk_bf16_f32 v244, v248, v249
    v_cvt_pk_bf16_f32 v245, v250, v251
    buffer_store_dwordx4 v[240:243], v18, s[32:35], 0 offen sc1
    s_mov_b64 exec, s[66:67]
    buffer_store_dwordx2 v[244:245], v19, s[32:35], 0 offen sc1
    s_mov_b64 exec, -1
    s_mul_i32 s54, s50, 160
    s_movk_i32 s56, 6554
    s_movk_i32 s57, 1280
    v_add_u32 v4, 0, v1
    v_mul_u32_u24 v8, s56, v4
    v_lshrrev_b32 v8, 16, v8
    v_mul_u32_u24 v9, 10, v8
    v_sub_u32 v9, v4, v9
    v_mul_u32_u24 v8, s57, v8
    v_lshl_add_u32 v8, v9, 4, v8
    v_add_u32 v10, s54, v8
    v_add_u32 v4, 64, v1
    v_mul_u32_u24 v8, s56, v4
    v_lshrrev_b32 v8, 16, v8
    v_mul_u32_u24 v9, 10, v8
    v_sub_u32 v9, v4, v9
    v_mul_u32_u24 v8, s57, v8
    v_lshl_add_u32 v8, v9, 4, v8
    v_add_u32 v11, s54, v8
    v_add_u32 v4, 128, v1
    v_mul_u32_u24 v8, s56, v4
    v_lshrrev_b32 v8, 16, v8
    v_mul_u32_u24 v9, 10, v8
    v_sub_u32 v9, v4, v9
    v_mul_u32_u24 v8, s57, v8
    v_lshl_add_u32 v8, v9, 4, v8
    v_add_u32 v12, s54, v8
    v_add_u32 v4, 192, v1
    v_mul_u32_u24 v8, s56, v4
    v_lshrrev_b32 v8, 16, v8
    v_mul_u32_u24 v9, 10, v8
    v_sub_u32 v9, v4, v9
    v_mul_u32_u24 v8, s57, v8
    v_lshl_add_u32 v8, v9, 4, v8
    v_add_u32 v13, s54, v8
    v_add_u32 v4, 256, v1
    v_mul_u32_u24 v8, s56, v4
    v_lshrrev_b32 v8, 16, v8
    v_mul_u32_u24 v9, 10, v8
    v_sub_u32 v9, v4, v9
    v_mul_u32_u24 v8, s57, v8
    v_lshl_add_u32 v8, v9, 4, v8
    v_add_u32 v14, s54, v8
    s_mul_i32 s54, s50, 160
    v_lshrrev_b32 v4, 1, v3
    v_and_b32 v5, 1, v3
    v_lshrrev_b32 v6, 2, v2
    v_and_b32 v7, 3, v2
    v_mul_u32_u24 v8, 20, v4
    v_lshl_add_u32 v8, v5, 2, v8
    v_add_u32 v8, v8, v6
    s_movk_i32 s55, 160
    v_mul_u32_u24 v8, s55, v8
    v_lshl_add_u32 v8, v7, 3, v8
    s_mul_i32 s56, s53, 51200
    v_add_u32 v20, s56, v8
    v_mul_u32_u24 v8, 40, v3
    v_add3_u32 v8, v8, v6, 16
    v_mul_u32_u24 v8, s55, v8
    v_lshl_add_u32 v8, v7, 3, v8
    v_add_u32 v21, s56, v8
    v_lshlrev_b32 v22, 4, v1
    s_lshl_b32 s56, s52, 4
    v_add_u32 v8, s56, v2
    s_movk_i32 s56, 2560
    v_mul_u32_u24 v8, s56, v8
    v_lshl_add_u32 v8, v3, 3, v8
    v_add_u32 v23, s54, v8
    s_mul_i32 s56, s52, 10240
    s_add_u32 s56, s56, 102400
    v_add_u32 v24, s56, v22
    s_lshl_b32 s60, s49, 7
    s_barrier
    s_add_u32 s23, s51, 0
    s_mul_i32 s61, s51, 40960
    s_mul_i32 s23, s51, 5120
    s_add_u32 m0, s23, 0
    s_mul_i32 s61, s51, 40960
    buffer_load_dwordx4 v10, s[40:43], s61 offen  lds
    s_add_u32 m0, s23, 1024
    s_mul_i32 s61, s51, 40960
    buffer_load_dwordx4 v11, s[40:43], s61 offen  lds
    s_waitcnt vmcnt(2)
    s_lshl_b32 s54, s49, 1
    s_add_u32 s54, s54, 1
    s_lshl_b32 s54, s54, 3
    s_add_u32 s54, s54, s50
    s_lshl_b32 s54, s54, 5
    s_add_u32 s54, s54, s51
    s_lshl_b32 s54, s54, 2
    s_add_u32 s54, s54, 16814080
    v_mov_b32 v4, s3
    v_mov_b32 v5, 0
    s_mov_b64 exec, 1
    buffer_store_dword v4, v5, s[32:35], s54 offen sc0 sc1
    s_mov_b64 exec, -1
    s_add_u32 m0, s23, 2048
    s_mul_i32 s61, s51, 40960
    buffer_load_dwordx4 v12, s[40:43], s61 offen  lds
    s_add_u32 m0, s23, 3072
    s_mul_i32 s61, s51, 40960
    buffer_load_dwordx4 v13, s[40:43], s61 offen  lds
    s_add_u32 m0, s23, 4096
    s_mul_i32 s61, s51, 40960
    buffer_load_dwordx4 v14, s[40:43], s61 offen  lds
    s_lshr_b32 s54, s60, 4
    s_add_u32 s54, s54, s52
    s_add_u32 s54, s54, 0
    s_mul_i32 s54, s54, 20480
    s_add_u32 s54, s54, 10485760
    s_lshl_b32 s55, s53, 13
    s_add_u32 s55, s55, s54
    s_add_u32 s61, s55, 0
    buffer_load_dwordx4 v[32:35], v22, s[32:35], s61 offen sc1
    s_add_u32 s61, s55, 1024
    buffer_load_dwordx4 v[36:39], v22, s[32:35], s61 offen sc1
    s_add_u32 s61, s55, 2048
    buffer_load_dwordx4 v[40:43], v22, s[32:35], s61 offen sc1
    s_add_u32 s61, s55, 3072
    buffer_load_dwordx4 v[44:47], v22, s[32:35], s61 offen sc1
    s_add_u32 s61, s55, 4096
    buffer_load_dwordx4 v[48:51], v22, s[32:35], s61 offen sc1
    s_add_u32 s61, s55, 5120
    buffer_load_dwordx4 v[52:55], v22, s[32:35], s61 offen sc1
    s_add_u32 s61, s55, 6144
    buffer_load_dwordx4 v[56:59], v22, s[32:35], s61 offen sc1
    s_add_u32 s61, s55, 7168
    buffer_load_dwordx4 v[60:63], v22, s[32:35], s61 offen sc1
    s_lshl_b32 s55, s53, 11
    s_add_u32 s55, s55, s54
    s_add_u32 s61, s55, 16384
    buffer_load_dwordx4 v[64:67], v22, s[32:35], s61 offen sc1
    s_add_u32 s61, s55, 17408
    buffer_load_dwordx4 v[68:71], v22, s[32:35], s61 offen sc1
    s_add_u32 s54, s51, 8
    s_mul_i32 s61, s54, 40960
    s_mul_i32 s54, s54, 5120
    s_add_u32 m0, s54, 0
    s_nop 0
    buffer_load_dwordx4 v10, s[40:43], s61 offen  lds
    s_add_u32 m0, s54, 1024
    s_nop 0
    buffer_load_dwordx4 v11, s[40:43], s61 offen  lds
    s_add_u32 m0, s54, 2048
    s_nop 0
    buffer_load_dwordx4 v12, s[40:43], s61 offen  lds
    s_add_u32 m0, s54, 3072
    s_nop 0
    buffer_load_dwordx4 v13, s[40:43], s61 offen  lds
    s_add_u32 m0, s54, 4096
    s_nop 0
    buffer_load_dwordx4 v14, s[40:43], s61 offen  lds
L_wol_245:
    s_add_u32 s54, s51, 16
    s_cmp_ge_u32 s54, 20
    s_cbranch_scc1 L_wol_246
    s_mul_i32 s61, s54, 40960
    s_mul_i32 s54, s54, 5120
    s_add_u32 m0, s54, 0
    s_nop 0
    buffer_load_dwordx4 v10, s[40:43], s61 offen  lds
    s_add_u32 m0, s54, 1024
    s_nop 0
    buffer_load_dwordx4 v11, s[40:43], s61 offen  lds
    s_add_u32 m0, s54, 2048
    s_nop 0
    buffer_load_dwordx4 v12, s[40:43], s61 offen  lds
    s_add_u32 m0, s54, 3072
    s_nop 0
    buffer_load_dwordx4 v13, s[40:43], s61 offen  lds
    s_add_u32 m0, s54, 4096
    s_nop 0
    buffer_load_dwordx4 v14, s[40:43], s61 offen  lds
L_wol_246:
    s_waitcnt vmcnt(0)
    s_barrier
    ds_read_b64_tr_b16 v[112:113], v20 offset:0
    ds_read_b64_tr_b16 v[114:115], v20 offset:1280
    ds_read_b64_tr_b16 v[116:117], v20 offset:32
    ds_read_b64_tr_b16 v[118:119], v20 offset:1312
    ds_read_b64_tr_b16 v[120:121], v20 offset:64
    ds_read_b64_tr_b16 v[122:123], v20 offset:1344
    ds_read_b64_tr_b16 v[124:125], v20 offset:96
    ds_read_b64_tr_b16 v[126:127], v20 offset:1376
    ds_read_b64_tr_b16 v[128:129], v20 offset:128
    ds_read_b64_tr_b16 v[130:131], v20 offset:1408
    ds_read_b64_tr_b16 v[132:133], v20 offset:6400
    ds_read_b64_tr_b16 v[134:135], v20 offset:7680
    ds_read_b64_tr_b16 v[136:137], v20 offset:6432
    ds_read_b64_tr_b16 v[138:139], v20 offset:7712
    ds_read_b64_tr_b16 v[140:141], v20 offset:6464
    ds_read_b64_tr_b16 v[142:143], v20 offset:7744
    ds_read_b64_tr_b16 v[144:145], v20 offset:6496
    ds_read_b64_tr_b16 v[146:147], v20 offset:7776
    ds_read_b64_tr_b16 v[148:149], v20 offset:6528
    ds_read_b64_tr_b16 v[150:151], v20 offset:7808
    s_waitcnt lgkmcnt(15)
    v_mfma_f32_16x16x32_bf16 v[172:175], v[112:115], v[32:35], 0
    ds_read_b64_tr_b16 v[152:153], v20 offset:12800
    ds_read_b64_tr_b16 v[154:155], v20 offset:14080
    v_mfma_f32_16x16x32_bf16 v[176:179], v[116:119], v[32:35], 0
    ds_read_b64_tr_b16 v[156:157], v20 offset:12832
    ds_read_b64_tr_b16 v[158:159], v20 offset:14112
    s_waitcnt lgkmcnt(15)
    v_mfma_f32_16x16x32_bf16 v[180:183], v[120:123], v[32:35], 0
    ds_read_b64_tr_b16 v[160:161], v20 offset:12864
    ds_read_b64_tr_b16 v[162:163], v20 offset:14144
    v_mfma_f32_16x16x32_bf16 v[184:187], v[124:127], v[32:35], 0
    ds_read_b64_tr_b16 v[164:165], v20 offset:12896
    ds_read_b64_tr_b16 v[166:167], v20 offset:14176
    s_waitcnt lgkmcnt(15)
    v_mfma_f32_16x16x32_bf16 v[188:191], v[128:131], v[32:35], 0
    ds_read_b64_tr_b16 v[168:169], v20 offset:12928
    ds_read_b64_tr_b16 v[170:171], v20 offset:14208
    v_mfma_f32_16x16x32_bf16 v[172:175], v[132:135], v[36:39], v[172:175]
    ds_read_b64_tr_b16 v[112:113], v20 offset:19200
    ds_read_b64_tr_b16 v[114:115], v20 offset:20480
    s_waitcnt lgkmcnt(15)
    v_mfma_f32_16x16x32_bf16 v[176:179], v[136:139], v[36:39], v[176:179]
    ds_read_b64_tr_b16 v[116:117], v20 offset:19232
    ds_read_b64_tr_b16 v[118:119], v20 offset:20512
    v_mfma_f32_16x16x32_bf16 v[180:183], v[140:143], v[36:39], v[180:183]
    ds_read_b64_tr_b16 v[120:121], v20 offset:19264
    ds_read_b64_tr_b16 v[122:123], v20 offset:20544
    s_waitcnt lgkmcnt(15)
    v_mfma_f32_16x16x32_bf16 v[184:187], v[144:147], v[36:39], v[184:187]
    ds_read_b64_tr_b16 v[124:125], v20 offset:19296
    ds_read_b64_tr_b16 v[126:127], v20 offset:20576
    v_mfma_f32_16x16x32_bf16 v[188:191], v[148:151], v[36:39], v[188:191]
    ds_read_b64_tr_b16 v[128:129], v20 offset:19328
    ds_read_b64_tr_b16 v[130:131], v20 offset:20608
    s_waitcnt lgkmcnt(15)
    v_mfma_f32_16x16x32_bf16 v[172:175], v[152:155], v[40:43], v[172:175]
    ds_read_b64_tr_b16 v[132:133], v20 offset:25600
    ds_read_b64_tr_b16 v[134:135], v20 offset:26880
    v_mfma_f32_16x16x32_bf16 v[176:179], v[156:159], v[40:43], v[176:179]
    ds_read_b64_tr_b16 v[136:137], v20 offset:25632
    ds_read_b64_tr_b16 v[138:139], v20 offset:26912
    s_waitcnt lgkmcnt(15)
    v_mfma_f32_16x16x32_bf16 v[180:183], v[160:163], v[40:43], v[180:183]
    ds_read_b64_tr_b16 v[140:141], v20 offset:25664
    ds_read_b64_tr_b16 v[142:143], v20 offset:26944
    v_mfma_f32_16x16x32_bf16 v[184:187], v[164:167], v[40:43], v[184:187]
    ds_read_b64_tr_b16 v[144:145], v20 offset:25696
    ds_read_b64_tr_b16 v[146:147], v20 offset:26976
    s_waitcnt lgkmcnt(15)
    v_mfma_f32_16x16x32_bf16 v[188:191], v[168:171], v[40:43], v[188:191]
    ds_read_b64_tr_b16 v[148:149], v20 offset:25728
    ds_read_b64_tr_b16 v[150:151], v20 offset:27008
    v_mfma_f32_16x16x32_bf16 v[172:175], v[112:115], v[44:47], v[172:175]
    ds_read_b64_tr_b16 v[152:153], v20 offset:32000
    ds_read_b64_tr_b16 v[154:155], v20 offset:33280
    s_waitcnt lgkmcnt(15)
    v_mfma_f32_16x16x32_bf16 v[176:179], v[116:119], v[44:47], v[176:179]
    ds_read_b64_tr_b16 v[156:157], v20 offset:32032
    ds_read_b64_tr_b16 v[158:159], v20 offset:33312
    v_mfma_f32_16x16x32_bf16 v[180:183], v[120:123], v[44:47], v[180:183]
    ds_read_b64_tr_b16 v[160:161], v20 offset:32064
    ds_read_b64_tr_b16 v[162:163], v20 offset:33344
    s_waitcnt lgkmcnt(15)
    v_mfma_f32_16x16x32_bf16 v[184:187], v[124:127], v[44:47], v[184:187]
    ds_read_b64_tr_b16 v[164:165], v20 offset:32096
    ds_read_b64_tr_b16 v[166:167], v20 offset:33376
    v_mfma_f32_16x16x32_bf16 v[188:191], v[128:131], v[44:47], v[188:191]
    ds_read_b64_tr_b16 v[168:169], v20 offset:32128
    ds_read_b64_tr_b16 v[170:171], v20 offset:33408
    s_waitcnt lgkmcnt(15)
    v_mfma_f32_16x16x32_bf16 v[172:175], v[132:135], v[48:51], v[172:175]
    ds_read_b64_tr_b16 v[112:113], v20 offset:38400
    ds_read_b64_tr_b16 v[114:115], v20 offset:39680
    v_mfma_f32_16x16x32_bf16 v[176:179], v[136:139], v[48:51], v[176:179]
    ds_read_b64_tr_b16 v[116:117], v20 offset:38432
    ds_read_b64_tr_b16 v[118:119], v20 offset:39712
    s_waitcnt lgkmcnt(15)
    v_mfma_f32_16x16x32_bf16 v[180:183], v[140:143], v[48:51], v[180:183]
    ds_read_b64_tr_b16 v[120:121], v20 offset:38464
    ds_read_b64_tr_b16 v[122:123], v20 offset:39744
    v_mfma_f32_16x16x32_bf16 v[184:187], v[144:147], v[48:51], v[184:187]
    ds_read_b64_tr_b16 v[124:125], v20 offset:38496
    ds_read_b64_tr_b16 v[126:127], v20 offset:39776
    s_waitcnt lgkmcnt(15)
    v_mfma_f32_16x16x32_bf16 v[188:191], v[148:151], v[48:51], v[188:191]
    ds_read_b64_tr_b16 v[128:129], v20 offset:38528
    ds_read_b64_tr_b16 v[130:131], v20 offset:39808
    v_mfma_f32_16x16x32_bf16 v[172:175], v[152:155], v[52:55], v[172:175]
    ds_read_b64_tr_b16 v[132:133], v20 offset:44800
    ds_read_b64_tr_b16 v[134:135], v20 offset:46080
    s_waitcnt lgkmcnt(15)
    v_mfma_f32_16x16x32_bf16 v[176:179], v[156:159], v[52:55], v[176:179]
    ds_read_b64_tr_b16 v[136:137], v20 offset:44832
    ds_read_b64_tr_b16 v[138:139], v20 offset:46112
    v_mfma_f32_16x16x32_bf16 v[180:183], v[160:163], v[52:55], v[180:183]
    ds_read_b64_tr_b16 v[140:141], v20 offset:44864
    ds_read_b64_tr_b16 v[142:143], v20 offset:46144
    s_waitcnt lgkmcnt(15)
    v_mfma_f32_16x16x32_bf16 v[184:187], v[164:167], v[52:55], v[184:187]
    ds_read_b64_tr_b16 v[144:145], v20 offset:44896
    ds_read_b64_tr_b16 v[146:147], v20 offset:46176
    v_mfma_f32_16x16x32_bf16 v[188:191], v[168:171], v[52:55], v[188:191]
    ds_read_b64_tr_b16 v[148:149], v20 offset:44928
    ds_read_b64_tr_b16 v[150:151], v20 offset:46208
    s_waitcnt lgkmcnt(15)
    v_mfma_f32_16x16x32_bf16 v[172:175], v[112:115], v[56:59], v[172:175]
    ds_read_b64_tr_b16 v[152:153], v21 offset:0
    ds_read_b64_tr_b16 v[154:155], v21 offset:3200
    v_mfma_f32_16x16x32_bf16 v[176:179], v[116:119], v[56:59], v[176:179]
    ds_read_b64_tr_b16 v[156:157], v21 offset:32
    ds_read_b64_tr_b16 v[158:159], v21 offset:3232
    s_waitcnt lgkmcnt(15)
    v_mfma_f32_16x16x32_bf16 v[180:183], v[120:123], v[56:59], v[180:183]
    ds_read_b64_tr_b16 v[160:161], v21 offset:64
    ds_read_b64_tr_b16 v[162:163], v21 offset:3264
    v_mfma_f32_16x16x32_bf16 v[184:187], v[124:127], v[56:59], v[184:187]
    ds_read_b64_tr_b16 v[164:165], v21 offset:96
    ds_read_b64_tr_b16 v[166:167], v21 offset:3296
    s_waitcnt lgkmcnt(15)
    v_mfma_f32_16x16x32_bf16 v[188:191], v[128:131], v[56:59], v[188:191]
    ds_read_b64_tr_b16 v[168:169], v21 offset:128
    ds_read_b64_tr_b16 v[170:171], v21 offset:3328
    v_mfma_f32_16x16x32_bf16 v[172:175], v[132:135], v[60:63], v[172:175]
    ds_read_b64_tr_b16 v[112:113], v21 offset:25600
    ds_read_b64_tr_b16 v[114:115], v21 offset:28800
    s_waitcnt lgkmcnt(15)
    v_mfma_f32_16x16x32_bf16 v[176:179], v[136:139], v[60:63], v[176:179]
    ds_read_b64_tr_b16 v[116:117], v21 offset:25632
    ds_read_b64_tr_b16 v[118:119], v21 offset:28832
    v_mfma_f32_16x16x32_bf16 v[180:183], v[140:143], v[60:63], v[180:183]
    ds_read_b64_tr_b16 v[120:121], v21 offset:25664
    ds_read_b64_tr_b16 v[122:123], v21 offset:28864
    s_waitcnt lgkmcnt(15)
    v_mfma_f32_16x16x32_bf16 v[184:187], v[144:147], v[60:63], v[184:187]
    ds_read_b64_tr_b16 v[124:125], v21 offset:25696
    ds_read_b64_tr_b16 v[126:127], v21 offset:28896
    v_mfma_f32_16x16x32_bf16 v[188:191], v[148:151], v[60:63], v[188:191]
    ds_read_b64_tr_b16 v[128:129], v21 offset:25728
    ds_read_b64_tr_b16 v[130:131], v21 offset:28928
    s_waitcnt lgkmcnt(15)
    v_mfma_f32_16x16x32_bf16 v[172:175], v[152:155], v[64:67], v[172:175]
    v_mfma_f32_16x16x32_bf16 v[176:179], v[156:159], v[64:67], v[176:179]
    s_waitcnt lgkmcnt(14)
    v_mfma_f32_16x16x32_bf16 v[180:183], v[160:163], v[64:67], v[180:183]
    s_waitcnt lgkmcnt(12)
    v_mfma_f32_16x16x32_bf16 v[184:187], v[164:167], v[64:67], v[184:187]
    s_waitcnt lgkmcnt(10)
    v_mfma_f32_16x16x32_bf16 v[188:191], v[168:171], v[64:67], v[188:191]
    s_waitcnt lgkmcnt(8)
    v_mfma_f32_16x16x32_bf16 v[172:175], v[112:115], v[68:71], v[172:175]
    s_waitcnt lgkmcnt(6)
    v_mfma_f32_16x16x32_bf16 v[176:179], v[116:119], v[68:71], v[176:179]
    s_waitcnt lgkmcnt(4)
    v_mfma_f32_16x16x32_bf16 v[180:183], v[120:123], v[68:71], v[180:183]
    s_waitcnt lgkmcnt(2)
    v_mfma_f32_16x16x32_bf16 v[184:187], v[124:127], v[68:71], v[184:187]
    s_waitcnt lgkmcnt(0)
    v_mfma_f32_16x16x32_bf16 v[188:191], v[128:131], v[68:71], v[188:191]
    s_lshl_b32 s54, s52, 4
    v_add_u32 v4, s54, v2
    s_movk_i32 s55, 160
    v_mul_u32_u24 v4, s55, v4
    v_lshl_add_u32 v4, v3, 3, v4
    v_add_u32 v4, 143360, v4
    s_nop 2
    s_cmp_eq_u32 s53, 0
    s_cbranch_scc0 L_rx_247
    ds_write_b128 v24, v[184:187] offset:3072
    ds_write_b128 v24, v[188:191] offset:4096
    s_branch L_rd_248
L_rx_247:
    ds_write_b128 v24, v[172:175] offset:0
    ds_write_b128 v24, v[176:179] offset:1024
    ds_write_b128 v24, v[180:183] offset:2048
L_rd_248:
    s_lshl_b32 s54, s51, 6
    v_add_u32 v5, s54, v1
    s_movk_i32 s56, 6554
    s_movk_i32 s57, 2560
    s_mul_i32 s58, s50, 160
    v_add_u32 v6, 0, v5
    v_mul_u32_u24 v7, s56, v6
    v_lshrrev_b32 v7, 16, v7
    v_mul_u32_u24 v8, 10, v7
    v_sub_u32 v8, v6, v8
    v_mul_u32_u24 v9, s55, v7
    v_lshl_add_u32 v9, v8, 4, v9
    v_add_u32 v212, 143360, v9
    v_mul_u32_u24 v9, s57, v7
    v_lshl_add_u32 v9, v8, 4, v9
    v_add_u32 v216, s58, v9
    v_add_u32 v6, 512, v5
    v_mul_u32_u24 v7, s56, v6
    v_lshrrev_b32 v7, 16, v7
    v_mul_u32_u24 v8, 10, v7
    v_sub_u32 v8, v6, v8
    v_mul_u32_u24 v9, s55, v7
    v_lshl_add_u32 v9, v8, 4, v9
    v_add_u32 v213, 143360, v9
    v_mul_u32_u24 v9, s57, v7
    v_lshl_add_u32 v9, v8, 4, v9
    v_add_u32 v217, s58, v9
    s_waitcnt lgkmcnt(0)
    s_barrier
    s_cmp_eq_u32 s53, 0
    s_cbranch_scc0 L_rx_249
    ds_read_b128 v[112:115], v24 offset:0
    ds_read_b128 v[116:119], v24 offset:1024
    ds_read_b128 v[120:123], v24 offset:2048
    s_waitcnt lgkmcnt(0)
    v_pk_add_f32 v[172:173], v[172:173], v[112:113]
    v_pk_add_f32 v[174:175], v[174:175], v[114:115]
    v_cvt_pk_bf16_f32 v172, v172, v173
    v_cvt_pk_bf16_f32 v173, v174, v175
    ds_write_b64 v4, v[172:173] offset:0
    v_pk_add_f32 v[176:177], v[176:177], v[116:117]
    v_pk_add_f32 v[178:179], v[178:179], v[118:119]
    v_cvt_pk_bf16_f32 v176, v176, v177
    v_cvt_pk_bf16_f32 v177, v178, v179
    ds_write_b64 v4, v[176:177] offset:32
    v_pk_add_f32 v[180:181], v[180:181], v[120:121]
    v_pk_add_f32 v[182:183], v[182:183], v[122:123]
    v_cvt_pk_bf16_f32 v180, v180, v181
    v_cvt_pk_bf16_f32 v181, v182, v183
    ds_write_b64 v4, v[180:181] offset:64
    s_branch L_rd_250
L_rx_249:
    ds_read_b128 v[112:115], v24 offset:3072
    ds_read_b128 v[116:119], v24 offset:4096
    s_waitcnt lgkmcnt(0)
    v_pk_add_f32 v[184:185], v[184:185], v[112:113]
    v_pk_add_f32 v[186:187], v[186:187], v[114:115]
    v_cvt_pk_bf16_f32 v184, v184, v185
    v_cvt_pk_bf16_f32 v185, v186, v187
    ds_write_b64 v4, v[184:185] offset:96
    v_pk_add_f32 v[188:189], v[188:189], v[116:117]
    v_pk_add_f32 v[190:191], v[190:191], v[118:119]
    v_cvt_pk_bf16_f32 v188, v188, v189
    v_cvt_pk_bf16_f32 v189, v190, v191
    ds_write_b64 v4, v[188:189] offset:128
L_rd_250:
    s_mul_i32 s54, s60, 2560
    s_add_u32 s54, s54, 0
    s_waitcnt lgkmcnt(0)
    s_barrier
    ds_read_b128 v[32:35], v212 offset:0
L_fr_251:
    s_cmp_ge_u32 s51, 2
    s_cbranch_scc1 L_fr_252
    ds_read_b128 v[36:39], v213 offset:0
L_fr_252:
    s_waitcnt lgkmcnt(0)
    buffer_store_dwordx4 v[32:35], v216, s[36:39], s54 offen nt
L_fs_253:
    s_cmp_ge_u32 s51, 2
    s_cbranch_scc1 L_fs_254
    buffer_store_dwordx4 v[36:39], v217, s[36:39], s54 offen nt
L_fs_254:
    s_branch L_fin
L_fill_186:
    v_mov_b32 v96, 0xff61b1e6
    v_mov_b32 v97, v96
    v_mov_b32 v98, v96
    v_mov_b32 v99, v96
    v_mov_b32 v100, v96
    v_mov_b32 v101, v96
    v_mov_b32 v102, v96
    v_mov_b32 v103, v96
    v_mov_b32 v104, v96
    v_mov_b32 v105, v96
    v_mov_b32 v106, v96
    v_mov_b32 v107, v96
    v_mov_b32 v108, v96
    v_mov_b32 v109, v96
    v_mov_b32 v110, v96
    v_mov_b32 v111, v96
    s_branch L_fret_187
L_fill_190:
    v_mov_b32 v112, 0xff61b1e6
    v_mov_b32 v113, v112
    v_mov_b32 v114, v112
    v_mov_b32 v115, v112
    v_mov_b32 v116, v112
    v_mov_b32 v117, v112
    v_mov_b32 v118, v112
    v_mov_b32 v119, v112
    v_mov_b32 v120, v112
    v_mov_b32 v121, v112
    v_mov_b32 v122, v112
    v_mov_b32 v123, v112
    v_mov_b32 v124, v112
    v_mov_b32 v125, v112
    v_mov_b32 v126, v112
    v_mov_b32 v127, v112
    s_branch L_fret_191
L_fill_194:
    v_mov_b32 v128, 0xff61b1e6
    v_mov_b32 v129, v128
    v_mov_b32 v130, v128
    v_mov_b32 v131, v128
    v_mov_b32 v132, v128
    v_mov_b32 v133, v128
    v_mov_b32 v134, v128
    v_mov_b32 v135, v128
    v_mov_b32 v136, v128
    v_mov_b32 v137, v128
    v_mov_b32 v138, v128
    v_mov_b32 v139, v128
    v_mov_b32 v140, v128
    v_mov_b32 v141, v128
    v_mov_b32 v142, v128
    v_mov_b32 v143, v128
    s_branch L_fret_195
L_fill_198:
    v_mov_b32 v144, 0xff61b1e6
    v_mov_b32 v145, v144
    v_mov_b32 v146, v144
    v_mov_b32 v147, v144
    v_mov_b32 v148, v144
    v_mov_b32 v149, v144
    v_mov_b32 v150, v144
    v_mov_b32 v151, v144
    v_mov_b32 v152, v144
    v_mov_b32 v153, v144
    v_mov_b32 v154, v144
    v_mov_b32 v155, v144
    v_mov_b32 v156, v144
    v_mov_b32 v157, v144
    v_mov_b32 v158, v144
    v_mov_b32 v159, v144
    s_branch L_fret_199
L_fill_202:
    v_mov_b32 v160, 0xff61b1e6
    v_mov_b32 v161, v160
    v_mov_b32 v162, v160
    v_mov_b32 v163, v160
    v_mov_b32 v164, v160
    v_mov_b32 v165, v160
    v_mov_b32 v166, v160
    v_mov_b32 v167, v160
    v_mov_b32 v168, v160
    v_mov_b32 v169, v160
    v_mov_b32 v170, v160
    v_mov_b32 v171, v160
    v_mov_b32 v172, v160
    v_mov_b32 v173, v160
    v_mov_b32 v174, v160
    v_mov_b32 v175, v160
    s_branch L_fret_203
L_fill_206:
    v_mov_b32 v176, 0xff61b1e6
    v_mov_b32 v177, v176
    v_mov_b32 v178, v176
    v_mov_b32 v179, v176
    v_mov_b32 v180, v176
    v_mov_b32 v181, v176
    v_mov_b32 v182, v176
    v_mov_b32 v183, v176
    v_mov_b32 v184, v176
    v_mov_b32 v185, v176
    v_mov_b32 v186, v176
    v_mov_b32 v187, v176
    v_mov_b32 v188, v176
    v_mov_b32 v189, v176
    v_mov_b32 v190, v176
    v_mov_b32 v191, v176
    s_branch L_fret_207
L_fill_210:
    v_mov_b32 v192, 0xff61b1e6
    v_mov_b32 v193, v192
    v_mov_b32 v194, v192
    v_mov_b32 v195, v192
    v_mov_b32 v196, v192
    v_mov_b32 v197, v192
    v_mov_b32 v198, v192
    v_mov_b32 v199, v192
    v_mov_b32 v200, v192
    v_mov_b32 v201, v192
    v_mov_b32 v202, v192
    v_mov_b32 v203, v192
    v_mov_b32 v204, v192
    v_mov_b32 v205, v192
    v_mov_b32 v206, v192
    v_mov_b32 v207, v192
    s_branch L_fret_211
L_fill_214:
    v_mov_b32 v208, 0xff61b1e6
    v_mov_b32 v209, v208
    v_mov_b32 v210, v208
    v_mov_b32 v211, v208
    v_mov_b32 v212, v208
    v_mov_b32 v213, v208
    v_mov_b32 v214, v208
    v_mov_b32 v215, v208
    v_mov_b32 v216, v208
    v_mov_b32 v217, v208
    v_mov_b32 v218, v208
    v_mov_b32 v219, v208
    v_mov_b32 v220, v208
    v_mov_b32 v221, v208
    v_mov_b32 v222, v208
    v_mov_b32 v223, v208
    s_branch L_fret_215
L_fill_218:
    v_mov_b32 v96, 0xff61b1e6
    v_mov_b32 v97, v96
    v_mov_b32 v98, v96
    v_mov_b32 v99, v96
    v_mov_b32 v100, v96
    v_mov_b32 v101, v96
    v_mov_b32 v102, v96
    v_mov_b32 v103, v96
    v_mov_b32 v104, v96
    v_mov_b32 v105, v96
    v_mov_b32 v106, v96
    v_mov_b32 v107, v96
    v_mov_b32 v108, v96
    v_mov_b32 v109, v96
    v_mov_b32 v110, v96
    v_mov_b32 v111, v96
    s_branch L_fret_219
L_fill_221:
    v_mov_b32 v112, 0xff61b1e6
    v_mov_b32 v113, v112
    v_mov_b32 v114, v112
    v_mov_b32 v115, v112
    v_mov_b32 v116, v112
    v_mov_b32 v117, v112
    v_mov_b32 v118, v112
    v_mov_b32 v119, v112
    v_mov_b32 v120, v112
    v_mov_b32 v121, v112
    v_mov_b32 v122, v112
    v_mov_b32 v123, v112
    v_mov_b32 v124, v112
    v_mov_b32 v125, v112
    v_mov_b32 v126, v112
    v_mov_b32 v127, v112
    s_branch L_fret_222
L_fill_224:
    v_mov_b32 v128, 0xff61b1e6
    v_mov_b32 v129, v128
    v_mov_b32 v130, v128
    v_mov_b32 v131, v128
    v_mov_b32 v132, v128
    v_mov_b32 v133, v128
    v_mov_b32 v134, v128
    v_mov_b32 v135, v128
    v_mov_b32 v136, v128
    v_mov_b32 v137, v128
    v_mov_b32 v138, v128
    v_mov_b32 v139, v128
    v_mov_b32 v140, v128
    v_mov_b32 v141, v128
    v_mov_b32 v142, v128
    v_mov_b32 v143, v128
    s_branch L_fret_225
L_fill_227:
    v_mov_b32 v144, 0xff61b1e6
    v_mov_b32 v145, v144
    v_mov_b32 v146, v144
    v_mov_b32 v147, v144
    v_mov_b32 v148, v144
    v_mov_b32 v149, v144
    v_mov_b32 v150, v144
    v_mov_b32 v151, v144
    v_mov_b32 v152, v144
    v_mov_b32 v153, v144
    v_mov_b32 v154, v144
    v_mov_b32 v155, v144
    v_mov_b32 v156, v144
    v_mov_b32 v157, v144
    v_mov_b32 v158, v144
    v_mov_b32 v159, v144
    s_branch L_fret_228
L_fill_230:
    v_mov_b32 v160, 0xff61b1e6
    v_mov_b32 v161, v160
    v_mov_b32 v162, v160
    v_mov_b32 v163, v160
    v_mov_b32 v164, v160
    v_mov_b32 v165, v160
    v_mov_b32 v166, v160
    v_mov_b32 v167, v160
    v_mov_b32 v168, v160
    v_mov_b32 v169, v160
    v_mov_b32 v170, v160
    v_mov_b32 v171, v160
    v_mov_b32 v172, v160
    v_mov_b32 v173, v160
    v_mov_b32 v174, v160
    v_mov_b32 v175, v160
    s_branch L_fret_231
L_fill_233:
    v_mov_b32 v176, 0xff61b1e6
    v_mov_b32 v177, v176
    v_mov_b32 v178, v176
    v_mov_b32 v179, v176
    v_mov_b32 v180, v176
    v_mov_b32 v181, v176
    v_mov_b32 v182, v176
    v_mov_b32 v183, v176
    v_mov_b32 v184, v176
    v_mov_b32 v185, v176
    v_mov_b32 v186, v176
    v_mov_b32 v187, v176
    v_mov_b32 v188, v176
    v_mov_b32 v189, v176
    v_mov_b32 v190, v176
    v_mov_b32 v191, v176
    s_branch L_fret_234
L_fill_236:
    v_mov_b32 v192, 0xff61b1e6
    v_mov_b32 v193, v192
    v_mov_b32 v194, v192
    v_mov_b32 v195, v192
    v_mov_b32 v196, v192
    v_mov_b32 v197, v192
    v_mov_b32 v198, v192
    v_mov_b32 v199, v192
    v_mov_b32 v200, v192
    v_mov_b32 v201, v192
    v_mov_b32 v202, v192
    v_mov_b32 v203, v192
    v_mov_b32 v204, v192
    v_mov_b32 v205, v192
    v_mov_b32 v206, v192
    v_mov_b32 v207, v192
    s_branch L_fret_237
L_fill_239:
    v_mov_b32 v208, 0xff61b1e6
    v_mov_b32 v209, v208
    v_mov_b32 v210, v208
    v_mov_b32 v211, v208
    v_mov_b32 v212, v208
    v_mov_b32 v213, v208
    v_mov_b32 v214, v208
    v_mov_b32 v215, v208
    v_mov_b32 v216, v208
    v_mov_b32 v217, v208
    v_mov_b32 v218, v208
    v_mov_b32 v219, v208
    v_mov_b32 v220, v208
    v_mov_b32 v221, v208
    v_mov_b32 v222, v208
    v_mov_b32 v223, v208
    s_branch L_fret_240
L_brB_182:
    s_mov_b64 exec, s[80:81]
    s_add_u32 s61, s82, 57344
    buffer_load_dwordx2 v[188:189], v88, s[32:35], s61 offen sc1
    s_add_u32 s61, s82, 61440
    buffer_load_dwordx2 v[190:191], v88, s[32:35], s61 offen sc1
    s_mov_b64 exec, -1
    s_add_u32 s54, s51, 12
    s_mul_i32 s61, s54, 40960
    s_mul_i32 s54, s54, 5120
    s_add_u32 m0, s54, 0
    s_nop 0
    buffer_load_dwordx4 v10, s[44:47], s61 offen  lds
    s_add_u32 m0, s54, 1024
    s_nop 0
    buffer_load_dwordx4 v11, s[44:47], s61 offen  lds
    s_add_u32 m0, s54, 2048
    s_nop 0
    buffer_load_dwordx4 v12, s[44:47], s61 offen  lds
    s_add_u32 m0, s54, 3072
    s_nop 0
    buffer_load_dwordx4 v13, s[44:47], s61 offen  lds
    s_add_u32 m0, s54, 4096
    s_nop 0
    buffer_load_dwordx4 v14, s[44:47], s61 offen  lds
L_wol_255:
    s_mov_b32 s64, 0
    s_mov_b32 s65, -1
    s_mov_b32 s66, -1
    s_mov_b32 s67, 0
    v_mov_b32 v38, 0
    v_mov_b32 v39, 0
    s_lshr_b32 s55, s51, 1
    s_lshl_b32 s55, s55, 11
    v_lshlrev_b32 v8, 1, v88
    v_add_u32 v8, 135168, v8
    v_add_u32 v8, s55, v8
    v_and_b32 v4, 31, v1
    v_min_u32 v4, 20, v4
    v_lshrrev_b32 v5, 5, v1
    v_mul_u32_u24 v6, 48, v5
    v_add_u32 v6, v6, v4
    s_and_b32 s54, s51, 3
    s_lshl_b32 s54, s54, 11
    s_add_u32 s54, s54, 135168
    v_lshlrev_b32 v6, 4, v6
    v_add_u32 v6, s54, v6
    v_lshlrev_b32 v7, 4, v4
    v_add_u32 v7, s54, v7
    s_mov_b32 s56, 0xffff0000
    s_waitcnt vmcnt(5)
    v_lshlrev_b32 v192, 16, v160
    v_and_b32 v193, s56, v160
    v_lshlrev_b32 v194, 16, v161
    v_and_b32 v195, s56, v161
    v_lshlrev_b32 v196, 16, v162
    v_and_b32 v197, s56, v162
    v_lshlrev_b32 v198, 16, v163
    v_and_b32 v199, s56, v163
    v_lshlrev_b32 v200, 16, v164
    v_and_b32 v201, s56, v164
    v_pk_add_f32 v[192:193], v[192:193], v[200:201]
    v_lshlrev_b32 v200, 16, v165
    v_and_b32 v201, s56, v165
    v_pk_add_f32 v[194:195], v[194:195], v[200:201]
    v_lshlrev_b32 v200, 16, v166
    v_and_b32 v201, s56, v166
    v_pk_add_f32 v[196:197], v[196:197], v[200:201]
    v_lshlrev_b32 v200, 16, v167
    v_and_b32 v201, s56, v167
    v_pk_add_f32 v[198:199], v[198:199], v[200:201]
    v_lshlrev_b32 v200, 16, v168
    v_and_b32 v201, s56, v168
    v_pk_add_f32 v[192:193], v[192:193], v[200:201]
    v_lshlrev_b32 v200, 16, v169
    v_and_b32 v201, s56, v169
    v_pk_add_f32 v[194:195], v[194:195], v[200:201]
    v_lshlrev_b32 v200, 16, v170
    v_and_b32 v201, s56, v170
    v_pk_add_f32 v[196:197], v[196:197], v[200:201]
    v_lshlrev_b32 v200, 16, v171
    v_and_b32 v201, s56, v171
    v_pk_add_f32 v[198:199], v[198:199], v[200:201]
    v_lshlrev_b32 v200, 16, v172
    v_and_b32 v201, s56, v172
    v_pk_add_f32 v[192:193], v[192:193], v[200:201]
    v_lshlrev_b32 v200, 16, v173
    v_and_b32 v201, s56, v173
    v_pk_add_f32 v[194:195], v[194:195], v[200:201]
    v_lshlrev_b32 v200, 16, v174
    v_and_b32 v201, s56, v174
    v_pk_add_f32 v[196:197], v[196:197], v[200:201]
    v_lshlrev_b32 v200, 16, v175
    v_and_b32 v201, s56, v175
    v_pk_add_f32 v[198:199], v[198:199], v[200:201]
    v_lshlrev_b32 v200, 16, v176
    v_and_b32 v201, s56, v176
    v_pk_add_f32 v[192:193], v[192:193], v[200:201]
    v_lshlrev_b32 v200, 16, v177
    v_and_b32 v201, s56, v177
    v_pk_add_f32 v[194:195], v[194:195], v[200:201]
    v_lshlrev_b32 v200, 16, v178
    v_and_b32 v201, s56, v178
    v_pk_add_f32 v[196:197], v[196:197], v[200:201]
    v_lshlrev_b32 v200, 16, v179
    v_and_b32 v201, s56, v179
    v_pk_add_f32 v[198:199], v[198:199], v[200:201]
    v_lshlrev_b32 v200, 16, v180
    v_and_b32 v201, s56, v180
    v_pk_add_f32 v[192:193], v[192:193], v[200:201]
    v_lshlrev_b32 v200, 16, v181
    v_and_b32 v201, s56, v181
    v_pk_add_f32 v[194:195], v[194:195], v[200:201]
    v_lshlrev_b32 v200, 16, v182
    v_and_b32 v201, s56, v182
    v_pk_add_f32 v[196:197], v[196:197], v[200:201]
    v_lshlrev_b32 v200, 16, v183
    v_and_b32 v201, s56, v183
    v_pk_add_f32 v[198:199], v[198:199], v[200:201]
    v_lshlrev_b32 v200, 16, v184
    v_and_b32 v201, s56, v184
    v_pk_add_f32 v[192:193], v[192:193], v[200:201]
    v_lshlrev_b32 v200, 16, v185
    v_and_b32 v201, s56, v185
    v_pk_add_f32 v[194:195], v[194:195], v[200:201]
    v_lshlrev_b32 v200, 16, v186
    v_and_b32 v201, s56, v186
    v_pk_add_f32 v[196:197], v[196:197], v[200:201]
    v_lshlrev_b32 v200, 16, v187
    v_and_b32 v201, s56, v187
    v_pk_add_f32 v[198:199], v[198:199], v[200:201]
    v_lshlrev_b32 v200, 16, v188
    v_and_b32 v201, s56, v188
    v_pk_add_f32 v[192:193], v[192:193], v[200:201]
    v_lshlrev_b32 v200, 16, v189
    v_and_b32 v201, s56, v189
    v_pk_add_f32 v[194:195], v[194:195], v[200:201]
    v_lshlrev_b32 v200, 16, v190
    v_and_b32 v201, s56, v190
    v_pk_add_f32 v[196:197], v[196:197], v[200:201]
    v_lshlrev_b32 v200, 16, v191
    v_and_b32 v201, s56, v191
    v_pk_add_f32 v[198:199], v[198:199], v[200:201]
    v_pk_add_f32 v[192:193], v[192:193], v[196:197]
    v_pk_add_f32 v[194:195], v[194:195], v[198:199]
    s_barrier
    s_mov_b64 exec, s[80:81]
    ds_write_b128 v8, v[192:195]
    s_mov_b64 exec, -1
    s_waitcnt lgkmcnt(0)
    s_barrier
    ds_read_b128 v[40:43], v6
    ds_read_b128 v[44:47], v6 offset:384
    ds_read_b128 v[48:51], v7 offset:1536
    ds_read_b64_tr_b16 v[32:33], v15
    ds_read_b64_tr_b16 v[34:35], v16
    ds_read_b64_tr_b16 v[36:37], v17
    s_waitcnt lgkmcnt(3)
    v_cvt_pk_bf16_f32 v64, v40, v41
    v_cvt_pk_bf16_f32 v65, v42, v43
    v_cvt_pk_bf16_f32 v66, v44, v45
    v_cvt_pk_bf16_f32 v67, v46, v47
    v_cvt_pk_bf16_f32 v68, v48, v49
    v_cvt_pk_bf16_f32 v69, v50, v51
    v_mov_b32 v70, 0
    v_mov_b32 v71, 0
    s_waitcnt lgkmcnt(0)
    v_cndmask_b32_e64 v36, v36, 0, s[64:65]
    v_cndmask_b32_e64 v37, v37, 0, s[64:65]
    s_nop 1
    v_mfma_f32_32x32x16_bf16 v[240:255], v[64:67], v[32:35], 0
    v_mfma_f32_32x32x16_bf16 v[240:255], v[68:71], v[36:39], v[240:255]
    v_add_u32 v15, 10240, v15
    v_add_u32 v16, 10240, v16
    v_add_u32 v17, 10240, v17
    ds_read_b64_tr_b16 v[32:33], v15
    ds_read_b64_tr_b16 v[34:35], v16
    ds_read_b64_tr_b16 v[36:37], v17
    s_nop 9
    v_cndmask_b32_e64 v30, v252, v248, s[64:65]
    v_add_f32 v30, 0x358637bd, v30
    v_rcp_f32 v30, v30
    s_nop 0
    v_pk_mul_f32 v[240:241], v[240:241], v[30:31] op_sel_hi:[1,0]
    v_pk_mul_f32 v[242:243], v[242:243], v[30:31] op_sel_hi:[1,0]
    v_pk_mul_f32 v[244:245], v[244:245], v[30:31] op_sel_hi:[1,0]
    v_pk_mul_f32 v[246:247], v[246:247], v[30:31] op_sel_hi:[1,0]
    v_pk_mul_f32 v[248:249], v[248:249], v[30:31] op_sel_hi:[1,0]
    v_pk_mul_f32 v[250:251], v[250:251], v[30:31] op_sel_hi:[1,0]
    v_cvt_pk_bf16_f32 v240, v240, v241
    v_cvt_pk_bf16_f32 v241, v242, v243
    v_cvt_pk_bf16_f32 v242, v244, v245
    v_cvt_pk_bf16_f32 v243, v246, v247
    v_cvt_pk_bf16_f32 v244, v248, v249
    v_cvt_pk_bf16_f32 v245, v250, v251
    buffer_store_dwordx4 v[240:243], v18, s[32:35], 0 offen sc1
    s_mov_b64 exec, s[66:67]
    buffer_store_dwordx2 v[244:245], v19, s[32:35], 0 offen sc1
    s_mov_b64 exec, -1
    v_add_u32 v18, 81920, v18
    v_add_u32 v19, 81920, v19
    s_waitcnt lgkmcnt(0)
    v_cndmask_b32_e64 v36, v36, 0, s[64:65]
    v_cndmask_b32_e64 v37, v37, 0, s[64:65]
    s_nop 1
    v_mfma_f32_32x32x16_bf16 v[240:255], v[64:67], v[32:35], 0
    v_mfma_f32_32x32x16_bf16 v[240:255], v[68:71], v[36:39], v[240:255]
    s_nop 15
    v_cndmask_b32_e64 v30, v252, v248, s[64:65]
    v_add_f32 v30, 0x358637bd, v30
    v_rcp_f32 v30, v30
    s_nop 0
    v_pk_mul_f32 v[240:241], v[240:241], v[30:31] op_sel_hi:[1,0]
    v_pk_mul_f32 v[242:243], v[242:243], v[30:31] op_sel_hi:[1,0]
    v_pk_mul_f32 v[244:245], v[244:245], v[30:31] op_sel_hi:[1,0]
    v_pk_mul_f32 v[246:247], v[246:247], v[30:31] op_sel_hi:[1,0]
    v_pk_mul_f32 v[248:249], v[248:249], v[30:31] op_sel_hi:[1,0]
    v_pk_mul_f32 v[250:251], v[250:251], v[30:31] op_sel_hi:[1,0]
    v_cvt_pk_bf16_f32 v240, v240, v241
    v_cvt_pk_bf16_f32 v241, v242, v243
    v_cvt_pk_bf16_f32 v242, v244, v245
    v_cvt_pk_bf16_f32 v243, v246, v247
    v_cvt_pk_bf16_f32 v244, v248, v249
    v_cvt_pk_bf16_f32 v245, v250, v251
    buffer_store_dwordx4 v[240:243], v18, s[32:35], 0 offen sc1
    s_mov_b64 exec, s[66:67]
    buffer_store_dwordx2 v[244:245], v19, s[32:35], 0 offen sc1
    s_mov_b64 exec, -1
    s_mul_i32 s54, s50, 160
    v_lshrrev_b32 v4, 1, v3
    v_and_b32 v5, 1, v3
    v_lshrrev_b32 v6, 2, v2
    v_and_b32 v7, 3, v2
    v_mul_u32_u24 v8, 20, v4
    v_lshl_add_u32 v8, v5, 2, v8
    v_add_u32 v8, v8, v6
    s_movk_i32 s55, 160
    v_mul_u32_u24 v8, s55, v8
    v_lshl_add_u32 v8, v7, 3, v8
    s_mul_i32 s56, s53, 51200
    v_add_u32 v20, s56, v8
    v_mul_u32_u24 v8, 40, v3
    v_add3_u32 v8, v8, v6, 16
    v_mul_u32_u24 v8, s55, v8
    v_lshl_add_u32 v8, v7, 3, v8
    v_add_u32 v21, s56, v8
    v_lshlrev_b32 v22, 4, v1
    s_lshl_b32 s56, s52, 4
    v_add_u32 v8, s56, v2
    s_movk_i32 s56, 2560
    v_mul_u32_u24 v8, s56, v8
    v_lshl_add_u32 v8, v3, 3, v8
    v_add_u32 v23, s54, v8
    s_mul_i32 s56, s52, 10240
    s_add_u32 s56, s56, 102400
    v_add_u32 v24, s56, v22
    s_waitcnt vmcnt(0)
    s_barrier
    s_lshl_b32 s54, s49, 3
    s_add_u32 s54, s54, s50
    s_lshl_b32 s54, s54, 7
    s_add_u32 s54, s54, 16846848
    s_cmp_eq_u32 s51, 0
    s_cbranch_scc0 L_ow_256
    v_mov_b32 v4, s3
    v_mov_b32 v5, 0
    s_mov_b64 exec, 1
    buffer_store_dword v4, v5, s[32:35], s54 offen sc0 sc1
    s_mov_b64 exec, -1
L_ow_256:
    v_lshlrev_b32 v7, 7, v1
    s_lshl_b32 s54, s49, 10
    s_add_u32 s54, s54, 16846848
    s_cmp_eq_u32 s51, 0
    s_cbranch_scc0 L_ow_257
    s_mov_b32 exec_lo, 0xff
    s_mov_b32 exec_hi, 0
    s_mov_b32 s59, 0
L_pp_258:
    buffer_load_dword v6, v7, s[32:35], s54 offen sc1
    s_waitcnt vmcnt(0)
    v_cmp_ne_u32_e64 s[62:63], s3, v6
    s_add_u32 s59, s59, 1
    s_nop 1
    s_cmp_eq_u64 s[62:63], 0
    s_cbranch_scc1 L_pd_259
    s_sleep 1
    s_cmp_lt_u32 s59, 40000
    s_cbranch_scc1 L_pp_258
L_pd_259:
    s_mov_b64 exec, -1
L_ow_257:
    s_barrier
    s_lshl_b32 s60, s49, 7
    s_lshr_b32 s54, s60, 4
    s_add_u32 s54, s54, s52
    s_add_u32 s54, s54, 0
    s_mul_i32 s54, s54, 20480
    s_add_u32 s54, s54, 13107200
    s_lshl_b32 s55, s53, 13
    s_add_u32 s55, s55, s54
    s_add_u32 s61, s55, 0
    buffer_load_dwordx4 v[32:35], v22, s[32:35], s61 offen sc1
    s_add_u32 s61, s55, 1024
    buffer_load_dwordx4 v[36:39], v22, s[32:35], s61 offen sc1
    s_add_u32 s61, s55, 2048
    buffer_load_dwordx4 v[40:43], v22, s[32:35], s61 offen sc1
    s_add_u32 s61, s55, 3072
    buffer_load_dwordx4 v[44:47], v22, s[32:35], s61 offen sc1
    s_add_u32 s61, s55, 4096
    buffer_load_dwordx4 v[48:51], v22, s[32:35], s61 offen sc1
    s_add_u32 s61, s55, 5120
    buffer_load_dwordx4 v[52:55], v22, s[32:35], s61 offen sc1
    s_add_u32 s61, s55, 6144
    buffer_load_dwordx4 v[56:59], v22, s[32:35], s61 offen sc1
    s_add_u32 s61, s55, 7168
    buffer_load_dwordx4 v[60:63], v22, s[32:35], s61 offen sc1
    s_lshl_b32 s55, s53, 11
    s_add_u32 s55, s55, s54
    s_add_u32 s61, s55, 16384
    buffer_load_dwordx4 v[64:67], v22, s[32:35], s61 offen sc1
    s_add_u32 s61, s55, 17408
    buffer_load_dwordx4 v[68:71], v22, s[32:35], s61 offen sc1
    s_lshr_b32 s54, s60, 4
    s_add_u32 s54, s54, s52
    s_add_u32 s54, s54, 4
    s_mul_i32 s54, s54, 20480
    s_add_u32 s54, s54, 13107200
    s_lshl_b32 s55, s53, 13
    s_add_u32 s55, s55, s54
    s_add_u32 s61, s55, 0
    buffer_load_dwordx4 v[72:75], v22, s[32:35], s61 offen sc1
    s_add_u32 s61, s55, 1024
    buffer_load_dwordx4 v[76:79], v22, s[32:35], s61 offen sc1
    s_add_u32 s61, s55, 2048
    buffer_load_dwordx4 v[80:83], v22, s[32:35], s61 offen sc1
    s_add_u32 s61, s55, 3072
    buffer_load_dwordx4 v[84:87], v22, s[32:35], s61 offen sc1
    s_add_u32 s61, s55, 4096
    buffer_load_dwordx4 v[88:91], v22, s[32:35], s61 offen sc1
    s_add_u32 s61, s55, 5120
    buffer_load_dwordx4 v[92:95], v22, s[32:35], s61 offen sc1
    s_add_u32 s61, s55, 6144
    buffer_load_dwordx4 v[96:99], v22, s[32:35], s61 offen sc1
    s_add_u32 s61, s55, 7168
    buffer_load_dwordx4 v[100:103], v22, s[32:35], s61 offen sc1
    s_lshl_b32 s55, s53, 11
    s_add_u32 s55, s55, s54
    s_add_u32 s61, s55, 16384
    buffer_load_dwordx4 v[104:107], v22, s[32:35], s61 offen sc1
    s_add_u32 s61, s55, 17408
    buffer_load_dwordx4 v[108:111], v22, s[32:35], s61 offen sc1
    ds_read_b64_tr_b16 v[112:113], v20 offset:0
    ds_read_b64_tr_b16 v[114:115], v20 offset:1280
    ds_read_b64_tr_b16 v[116:117], v20 offset:32
    ds_read_b64_tr_b16 v[118:119], v20 offset:1312
    ds_read_b64_tr_b16 v[120:121], v20 offset:64
    ds_read_b64_tr_b16 v[122:123], v20 offset:1344
    ds_read_b64_tr_b16 v[124:125], v20 offset:96
    ds_read_b64_tr_b16 v[126:127], v20 offset:1376
    ds_read_b64_tr_b16 v[128:129], v20 offset:128
    ds_read_b64_tr_b16 v[130:131], v20 offset:1408
    ds_read_b64_tr_b16 v[132:133], v20 offset:6400
    ds_read_b64_tr_b16 v[134:135], v20 offset:7680
    ds_read_b64_tr_b16 v[136:137], v20 offset:6432
    ds_read_b64_tr_b16 v[138:139], v20 offset:7712
    ds_read_b64_tr_b16 v[140:141], v20 offset:6464
    ds_read_b64_tr_b16 v[142:143], v20 offset:7744
    ds_read_b64_tr_b16 v[144:145], v20 offset:6496
    ds_read_b64_tr_b16 v[146:147], v20 offset:7776
    ds_read_b64_tr_b16 v[148:149], v20 offset:6528
    ds_read_b64_tr_b16 v[150:151], v20 offset:7808
    s_waitcnt vmcnt(9)
    s_waitcnt lgkmcnt(15)
    v_mfma_f32_16x16x32_bf16 v[172:175], v[112:115], v[32:35], 0
    ds_read_b64_tr_b16 v[152:153], v20 offset:12800
    v_mfma_f32_16x16x32_bf16 v[192:195], v[112:115], v[72:75], 0
    ds_read_b64_tr_b16 v[154:155], v20 offset:14080
    v_mfma_f32_16x16x32_bf16 v[176:179], v[116:119], v[32:35], 0
    ds_read_b64_tr_b16 v[156:157], v20 offset:12832
    v_mfma_f32_16x16x32_bf16 v[196:199], v[116:119], v[72:75], 0
    ds_read_b64_tr_b16 v[158:159], v20 offset:14112
    s_waitcnt lgkmcnt(15)
    v_mfma_f32_16x16x32_bf16 v[180:183], v[120:123], v[32:35], 0
    ds_read_b64_tr_b16 v[160:161], v20 offset:12864
    v_mfma_f32_16x16x32_bf16 v[200:203], v[120:123], v[72:75], 0
    ds_read_b64_tr_b16 v[162:163], v20 offset:14144
    v_mfma_f32_16x16x32_bf16 v[184:187], v[124:127], v[32:35], 0
    ds_read_b64_tr_b16 v[164:165], v20 offset:12896
    v_mfma_f32_16x16x32_bf16 v[204:207], v[124:127], v[72:75], 0
    ds_read_b64_tr_b16 v[166:167], v20 offset:14176
    s_waitcnt lgkmcnt(15)
    v_mfma_f32_16x16x32_bf16 v[188:191], v[128:131], v[32:35], 0
    ds_read_b64_tr_b16 v[168:169], v20 offset:12928
    v_mfma_f32_16x16x32_bf16 v[208:211], v[128:131], v[72:75], 0
    ds_read_b64_tr_b16 v[170:171], v20 offset:14208
    s_waitcnt vmcnt(8)
    v_mfma_f32_16x16x32_bf16 v[172:175], v[132:135], v[36:39], v[172:175]
    ds_read_b64_tr_b16 v[112:113], v20 offset:19200
    v_mfma_f32_16x16x32_bf16 v[192:195], v[132:135], v[76:79], v[192:195]
    ds_read_b64_tr_b16 v[114:115], v20 offset:20480
    s_waitcnt lgkmcnt(15)
    v_mfma_f32_16x16x32_bf16 v[176:179], v[136:139], v[36:39], v[176:179]
    ds_read_b64_tr_b16 v[116:117], v20 offset:19232
    v_mfma_f32_16x16x32_bf16 v[196:199], v[136:139], v[76:79], v[196:199]
    ds_read_b64_tr_b16 v[118:119], v20 offset:20512
    v_mfma_f32_16x16x32_bf16 v[180:183], v[140:143], v[36:39], v[180:183]
    ds_read_b64_tr_b16 v[120:121], v20 offset:19264
    v_mfma_f32_16x16x32_bf16 v[200:203], v[140:143], v[76:79], v[200:203]
    ds_read_b64_tr_b16 v[122:123], v20 offset:20544
    s_waitcnt lgkmcnt(15)
    v_mfma_f32_16x16x32_bf16 v[184:187], v[144:147], v[36:39], v[184:187]
    ds_read_b64_tr_b16 v[124:125], v20 offset:19296
    v_mfma_f32_16x16x32_bf16 v[204:207], v[144:147], v[76:79], v[204:207]
    ds_read_b64_tr_b16 v[126:127], v20 offset:20576
    v_mfma_f32_16x16x32_bf16 v[188:191], v[148:151], v[36:39], v[188:191]
    ds_read_b64_tr_b16 v[128:129], v20 offset:19328
    v_mfma_f32_16x16x32_bf16 v[208:211], v[148:151], v[76:79], v[208:211]
    ds_read_b64_tr_b16 v[130:131], v20 offset:20608
    s_waitcnt vmcnt(7)
    s_waitcnt lgkmcnt(15)
    v_mfma_f32_16x16x32_bf16 v[172:175], v[152:155], v[40:43], v[172:175]
    ds_read_b64_tr_b16 v[132:133], v20 offset:25600
    v_mfma_f32_16x16x32_bf16 v[192:195], v[152:155], v[80:83], v[192:195]
    ds_read_b64_tr_b16 v[134:135], v20 offset:26880
    v_mfma_f32_16x16x32_bf16 v[176:179], v[156:159], v[40:43], v[176:179]
    ds_read_b64_tr_b16 v[136:137], v20 offset:25632
    v_mfma_f32_16x16x32_bf16 v[196:199], v[156:159], v[80:83], v[196:199]
    ds_read_b64_tr_b16 v[138:139], v20 offset:26912
    s_waitcnt lgkmcnt(15)
    v_mfma_f32_16x16x32_bf16 v[180:183], v[160:163], v[40:43], v[180:183]
    ds_read_b64_tr_b16 v[140:141], v20 offset:25664
    v_mfma_f32_16x16x32_bf16 v[200:203], v[160:163], v[80:83], v[200:203]
    ds_read_b64_tr_b16 v[142:143], v20 offset:26944
    v_mfma_f32_16x16x32_bf16 v[184:187], v[164:167], v[40:43], v[184:187]
    ds_read_b64_tr_b16 v[144:145], v20 offset:25696
    v_mfma_f32_16x16x32_bf16 v[204:207], v[164:167], v[80:83], v[204:207]
    ds_read_b64_tr_b16 v[146:147], v20 offset:26976
    s_waitcnt lgkmcnt(15)
    v_mfma_f32_16x16x32_bf16 v[188:191], v[168:171], v[40:43], v[188:191]
    ds_read_b64_tr_b16 v[148:149], v20 offset:25728
    v_mfma_f32_16x16x32_bf16 v[208:211], v[168:171], v[80:83], v[208:211]
    ds_read_b64_tr_b16 v[150:151], v20 offset:27008
    s_waitcnt vmcnt(6)
    v_mfma_f32_16x16x32_bf16 v[172:175], v[112:115], v[44:47], v[172:175]
    ds_read_b64_tr_b16 v[152:153], v20 offset:32000
    v_mfma_f32_16x16x32_bf16 v[192:195], v[112:115], v[84:87], v[192:195]
    ds_read_b64_tr_b16 v[154:155], v20 offset:33280
    s_waitcnt lgkmcnt(15)
    v_mfma_f32_16x16x32_bf16 v[176:179], v[116:119], v[44:47], v[176:179]
    ds_read_b64_tr_b16 v[156:157], v20 offset:32032
    v_mfma_f32_16x16x32_bf16 v[196:199], v[116:119], v[84:87], v[196:199]
    ds_read_b64_tr_b16 v[158:159], v20 offset:33312
    v_mfma_f32_16x16x32_bf16 v[180:183], v[120:123], v[44:47], v[180:183]
    ds_read_b64_tr_b16 v[160:161], v20 offset:32064
    v_mfma_f32_16x16x32_bf16 v[200:203], v[120:123], v[84:87], v[200:203]
    ds_read_b64_tr_b16 v[162:163], v20 offset:33344
    s_waitcnt lgkmcnt(15)
    v_mfma_f32_16x16x32_bf16 v[184:187], v[124:127], v[44:47], v[184:187]
    ds_read_b64_tr_b16 v[164:165], v20 offset:32096
    v_mfma_f32_16x16x32_bf16 v[204:207], v[124:127], v[84:87], v[204:207]
    ds_read_b64_tr_b16 v[166:167], v20 offset:33376
    v_mfma_f32_16x16x32_bf16 v[188:191], v[128:131], v[44:47], v[188:191]
    ds_read_b64_tr_b16 v[168:169], v20 offset:32128
    v_mfma_f32_16x16x32_bf16 v[208:211], v[128:131], v[84:87], v[208:211]
    ds_read_b64_tr_b16 v[170:171], v20 offset:33408
    s_waitcnt vmcnt(5)
    s_waitcnt lgkmcnt(15)
    v_mfma_f32_16x16x32_bf16 v[172:175], v[132:135], v[48:51], v[172:175]
    ds_read_b64_tr_b16 v[112:113], v20 offset:38400
    v_mfma_f32_16x16x32_bf16 v[192:195], v[132:135], v[88:91], v[192:195]
    ds_read_b64_tr_b16 v[114:115], v20 offset:39680
    v_mfma_f32_16x16x32_bf16 v[176:179], v[136:139], v[48:51], v[176:179]
    ds_read_b64_tr_b16 v[116:117], v20 offset:38432
    v_mfma_f32_16x16x32_bf16 v[196:199], v[136:139], v[88:91], v[196:199]
    ds_read_b64_tr_b16 v[118:119], v20 offset:39712
    s_waitcnt lgkmcnt(15)
    v_mfma_f32_16x16x32_bf16 v[180:183], v[140:143], v[48:51], v[180:183]
    ds_read_b64_tr_b16 v[120:121], v20 offset:38464
    v_mfma_f32_16x16x32_bf16 v[200:203], v[140:143], v[88:91], v[200:203]
    ds_read_b64_tr_b16 v[122:123], v20 offset:39744
    v_mfma_f32_16x16x32_bf16 v[184:187], v[144:147], v[48:51], v[184:187]
    ds_read_b64_tr_b16 v[124:125], v20 offset:38496
    v_mfma_f32_16x16x32_bf16 v[204:207], v[144:147], v[88:91], v[204:207]
    ds_read_b64_tr_b16 v[126:127], v20 offset:39776
    s_waitcnt lgkmcnt(15)
    v_mfma_f32_16x16x32_bf16 v[188:191], v[148:151], v[48:51], v[188:191]
    ds_read_b64_tr_b16 v[128:129], v20 offset:38528
    v_mfma_f32_16x16x32_bf16 v[208:211], v[148:151], v[88:91], v[208:211]
    ds_read_b64_tr_b16 v[130:131], v20 offset:39808
    s_waitcnt vmcnt(4)
    v_mfma_f32_16x16x32_bf16 v[172:175], v[152:155], v[52:55], v[172:175]
    ds_read_b64_tr_b16 v[132:133], v20 offset:44800
    v_mfma_f32_16x16x32_bf16 v[192:195], v[152:155], v[92:95], v[192:195]
    ds_read_b64_tr_b16 v[134:135], v20 offset:46080
    s_waitcnt lgkmcnt(15)
    v_mfma_f32_16x16x32_bf16 v[176:179], v[156:159], v[52:55], v[176:179]
    ds_read_b64_tr_b16 v[136:137], v20 offset:44832
    v_mfma_f32_16x16x32_bf16 v[196:199], v[156:159], v[92:95], v[196:199]
    ds_read_b64_tr_b16 v[138:139], v20 offset:46112
    v_mfma_f32_16x16x32_bf16 v[180:183], v[160:163], v[52:55], v[180:183]
    ds_read_b64_tr_b16 v[140:141], v20 offset:44864
    v_mfma_f32_16x16x32_bf16 v[200:203], v[160:163], v[92:95], v[200:203]
    ds_read_b64_tr_b16 v[142:143], v20 offset:46144
    s_waitcnt lgkmcnt(15)
    v_mfma_f32_16x16x32_bf16 v[184:187], v[164:167], v[52:55], v[184:187]
    ds_read_b64_tr_b16 v[144:145], v20 offset:44896
    v_mfma_f32_16x16x32_bf16 v[204:207], v[164:167], v[92:95], v[204:207]
    ds_read_b64_tr_b16 v[146:147], v20 offset:46176
    v_mfma_f32_16x16x32_bf16 v[188:191], v[168:171], v[52:55], v[188:191]
    ds_read_b64_tr_b16 v[148:149], v20 offset:44928
    v_mfma_f32_16x16x32_bf16 v[208:211], v[168:171], v[92:95], v[208:211]
    ds_read_b64_tr_b16 v[150:151], v20 offset:46208
    s_waitcnt vmcnt(3)
    s_waitcnt lgkmcnt(15)
    v_mfma_f32_16x16x32_bf16 v[172:175], v[112:115], v[56:59], v[172:175]
    ds_read_b64_tr_b16 v[152:153], v21 offset:0
    v_mfma_f32_16x16x32_bf16 v[192:195], v[112:115], v[96:99], v[192:195]
    ds_read_b64_tr_b16 v[154:155], v21 offset:3200
    v_mfma_f32_16x16x32_bf16 v[176:179], v[116:119], v[56:59], v[176:179]
    ds_read_b64_tr_b16 v[156:157], v21 offset:32
    v_mfma_f32_16x16x32_bf16 v[196:199], v[116:119], v[96:99], v[196:199]
    ds_read_b64_tr_b16 v[158:159], v21 offset:3232
    s_waitcnt lgkmcnt(15)
    v_mfma_f32_16x16x32_bf16 v[180:183], v[120:123], v[56:59], v[180:183]
    ds_read_b64_tr_b16 v[160:161], v21 offset:64
    v_mfma_f32_16x16x32_bf16 v[200:203], v[120:123], v[96:99], v[200:203]
    ds_read_b64_tr_b16 v[162:163], v21 offset:3264
    v_mfma_f32_16x16x32_bf16 v[184:187], v[124:127], v[56:59], v[184:187]
    ds_read_b64_tr_b16 v[164:165], v21 offset:96
    v_mfma_f32_16x16x32_bf16 v[204:207], v[124:127], v[96:99], v[204:207]
    ds_read_b64_tr_b16 v[166:167], v21 offset:3296
    s_waitcnt lgkmcnt(15)
    v_mfma_f32_16x16x32_bf16 v[188:191], v[128:131], v[56:59], v[188:191]
    ds_read_b64_tr_b16 v[168:169], v21 offset:128
    v_mfma_f32_16x16x32_bf16 v[208:211], v[128:131], v[96:99], v[208:211]
    ds_read_b64_tr_b16 v[170:171], v21 offset:3328
    s_waitcnt vmcnt(2)
    v_mfma_f32_16x16x32_bf16 v[172:175], v[132:135], v[60:63], v[172:175]
    ds_read_b64_tr_b16 v[112:113], v21 offset:25600
    v_mfma_f32_16x16x32_bf16 v[192:195], v[132:135], v[100:103], v[192:195]
    ds_read_b64_tr_b16 v[114:115], v21 offset:28800
    s_waitcnt lgkmcnt(15)
    v_mfma_f32_16x16x32_bf16 v[176:179], v[136:139], v[60:63], v[176:179]
    ds_read_b64_tr_b16 v[116:117], v21 offset:25632
    v_mfma_f32_16x16x32_bf16 v[196:199], v[136:139], v[100:103], v[196:199]
    ds_read_b64_tr_b16 v[118:119], v21 offset:28832
    v_mfma_f32_16x16x32_bf16 v[180:183], v[140:143], v[60:63], v[180:183]
    ds_read_b64_tr_b16 v[120:121], v21 offset:25664
    v_mfma_f32_16x16x32_bf16 v[200:203], v[140:143], v[100:103], v[200:203]
    ds_read_b64_tr_b16 v[122:123], v21 offset:28864
    s_waitcnt lgkmcnt(15)
    v_mfma_f32_16x16x32_bf16 v[184:187], v[144:147], v[60:63], v[184:187]
    ds_read_b64_tr_b16 v[124:125], v21 offset:25696
    v_mfma_f32_16x16x32_bf16 v[204:207], v[144:147], v[100:103], v[204:207]
    ds_read_b64_tr_b16 v[126:127], v21 offset:28896
    v_mfma_f32_16x16x32_bf16 v[188:191], v[148:151], v[60:63], v[188:191]
    ds_read_b64_tr_b16 v[128:129], v21 offset:25728
    v_mfma_f32_16x16x32_bf16 v[208:211], v[148:151], v[100:103], v[208:211]
    ds_read_b64_tr_b16 v[130:131], v21 offset:28928
    s_waitcnt vmcnt(1)
    s_waitcnt lgkmcnt(15)
    v_mfma_f32_16x16x32_bf16 v[172:175], v[152:155], v[64:67], v[172:175]
    v_mfma_f32_16x16x32_bf16 v[192:195], v[152:155], v[104:107], v[192:195]
    v_mfma_f32_16x16x32_bf16 v[176:179], v[156:159], v[64:67], v[176:179]
    v_mfma_f32_16x16x32_bf16 v[196:199], v[156:159], v[104:107], v[196:199]
    s_waitcnt lgkmcnt(14)
    v_mfma_f32_16x16x32_bf16 v[180:183], v[160:163], v[64:67], v[180:183]
    v_mfma_f32_16x16x32_bf16 v[200:203], v[160:163], v[104:107], v[200:203]
    s_waitcnt lgkmcnt(12)
    v_mfma_f32_16x16x32_bf16 v[184:187], v[164:167], v[64:67], v[184:187]
    v_mfma_f32_16x16x32_bf16 v[204:207], v[164:167], v[104:107], v[204:207]
    s_waitcnt lgkmcnt(10)
    v_mfma_f32_16x16x32_bf16 v[188:191], v[168:171], v[64:67], v[188:191]
    v_mfma_f32_16x16x32_bf16 v[208:211], v[168:171], v[104:107], v[208:211]
    s_waitcnt vmcnt(0)
    s_waitcnt lgkmcnt(8)
    v_mfma_f32_16x16x32_bf16 v[172:175], v[112:115], v[68:71], v[172:175]
    v_mfma_f32_16x16x32_bf16 v[192:195], v[112:115], v[108:111], v[192:195]
    s_waitcnt lgkmcnt(6)
    v_mfma_f32_16x16x32_bf16 v[176:179], v[116:119], v[68:71], v[176:179]
    v_mfma_f32_16x16x32_bf16 v[196:199], v[116:119], v[108:111], v[196:199]
    s_waitcnt lgkmcnt(4)
    v_mfma_f32_16x16x32_bf16 v[180:183], v[120:123], v[68:71], v[180:183]
    v_mfma_f32_16x16x32_bf16 v[200:203], v[120:123], v[108:111], v[200:203]
    s_waitcnt lgkmcnt(2)
    v_mfma_f32_16x16x32_bf16 v[184:187], v[124:127], v[68:71], v[184:187]
    v_mfma_f32_16x16x32_bf16 v[204:207], v[124:127], v[108:111], v[204:207]
    s_waitcnt lgkmcnt(0)
    v_mfma_f32_16x16x32_bf16 v[188:191], v[128:131], v[68:71], v[188:191]
    v_mfma_f32_16x16x32_bf16 v[208:211], v[128:131], v[108:111], v[208:211]
    s_lshl_b32 s54, s52, 4
    v_add_u32 v4, s54, v2
    s_movk_i32 s55, 160
    v_mul_u32_u24 v4, s55, v4
    v_lshl_add_u32 v4, v3, 3, v4
    v_add_u32 v4, 143360, v4
    s_nop 2
    s_cmp_eq_u32 s53, 0
    s_cbranch_scc0 L_rx_260
    ds_write_b128 v24, v[184:187] offset:3072
    ds_write_b128 v24, v[188:191] offset:4096
    ds_write_b128 v24, v[204:207] offset:8192
    ds_write_b128 v24, v[208:211] offset:9216
    s_branch L_rd_261
L_rx_260:
    ds_write_b128 v24, v[172:175] offset:0
    ds_write_b128 v24, v[176:179] offset:1024
    ds_write_b128 v24, v[180:183] offset:2048
    ds_write_b128 v24, v[192:195] offset:5120
    ds_write_b128 v24, v[196:199] offset:6144
    ds_write_b128 v24, v[200:203] offset:7168
L_rd_261:
    s_lshl_b32 s54, s51, 6
    v_add_u32 v5, s54, v1
    s_movk_i32 s56, 6554
    s_movk_i32 s57, 2560
    s_mul_i32 s58, s50, 160
    v_add_u32 v6, 0, v5
    v_mul_u32_u24 v7, s56, v6
    v_lshrrev_b32 v7, 16, v7
    v_mul_u32_u24 v8, 10, v7
    v_sub_u32 v8, v6, v8
    v_mul_u32_u24 v9, s55, v7
    v_lshl_add_u32 v9, v8, 4, v9
    v_add_u32 v212, 143360, v9
    v_mul_u32_u24 v9, s57, v7
    v_lshl_add_u32 v9, v8, 4, v9
    v_add_u32 v216, s58, v9
    v_add_u32 v6, 512, v5
    v_mul_u32_u24 v7, s56, v6
    v_lshrrev_b32 v7, 16, v7
    v_mul_u32_u24 v8, 10, v7
    v_sub_u32 v8, v6, v8
    v_mul_u32_u24 v9, s55, v7
    v_lshl_add_u32 v9, v8, 4, v9
    v_add_u32 v213, 143360, v9
    v_mul_u32_u24 v9, s57, v7
    v_lshl_add_u32 v9, v8, 4, v9
    v_add_u32 v217, s58, v9
    v_add_u32 v6, 1024, v5
    v_mul_u32_u24 v7, s56, v6
    v_lshrrev_b32 v7, 16, v7
    v_mul_u32_u24 v8, 10, v7
    v_sub_u32 v8, v6, v8
    v_mul_u32_u24 v9, s55, v7
    v_lshl_add_u32 v9, v8, 4, v9
    v_add_u32 v214, 143360, v9
    v_mul_u32_u24 v9, s57, v7
    v_lshl_add_u32 v9, v8, 4, v9
    v_add_u32 v218, s58, v9
    s_waitcnt lgkmcnt(0)
    s_barrier
    s_cmp_eq_u32 s51, 0
    s_cbranch_scc1 L_rf_262
    s_add_u32 s23, s51, 63
    s_sub_u32 s23, s23, 64
    s_mul_i32 s61, s23, 40960
    s_mul_i32 s23, s23, 5120
    s_add_u32 m0, s23, 0
    s_nop 0
    buffer_load_dwordx4 v10, s[40:43], s61 offen  lds
    s_add_u32 m0, s23, 1024
    s_nop 0
    buffer_load_dwordx4 v11, s[40:43], s61 offen  lds
    s_add_u32 m0, s23, 2048
    s_nop 0
    buffer_load_dwordx4 v12, s[40:43], s61 offen  lds
    s_add_u32 m0, s23, 3072
    s_nop 0
    buffer_load_dwordx4 v13, s[40:43], s61 offen  lds
    s_add_u32 m0, s23, 4096
    s_nop 0
    buffer_load_dwordx4 v14, s[40:43], s61 offen  lds
L_rf_262:
    s_cmp_eq_u32 s53, 0
    s_cbranch_scc0 L_rx_263
    ds_read_b128 v[112:115], v24 offset:0
    ds_read_b128 v[116:119], v24 offset:1024
    ds_read_b128 v[120:123], v24 offset:2048
    ds_read_b128 v[124:127], v24 offset:5120
    ds_read_b128 v[128:131], v24 offset:6144
    ds_read_b128 v[132:135], v24 offset:7168
    s_waitcnt lgkmcnt(0)
    v_pk_add_f32 v[172:173], v[172:173], v[112:113]
    v_pk_add_f32 v[174:175], v[174:175], v[114:115]
    v_cvt_pk_bf16_f32 v172, v172, v173
    v_cvt_pk_bf16_f32 v173, v174, v175
    ds_write_b64 v4, v[172:173] offset:0
    v_pk_add_f32 v[176:177], v[176:177], v[116:117]
    v_pk_add_f32 v[178:179], v[178:179], v[118:119]
    v_cvt_pk_bf16_f32 v176, v176, v177
    v_cvt_pk_bf16_f32 v177, v178, v179
    ds_write_b64 v4, v[176:177] offset:32
    v_pk_add_f32 v[180:181], v[180:181], v[120:121]
    v_pk_add_f32 v[182:183], v[182:183], v[122:123]
    v_cvt_pk_bf16_f32 v180, v180, v181
    v_cvt_pk_bf16_f32 v181, v182, v183
    ds_write_b64 v4, v[180:181] offset:64
    v_pk_add_f32 v[192:193], v[192:193], v[124:125]
    v_pk_add_f32 v[194:195], v[194:195], v[126:127]
    v_cvt_pk_bf16_f32 v192, v192, v193
    v_cvt_pk_bf16_f32 v193, v194, v195
    ds_write_b64 v4, v[192:193] offset:10240
    v_pk_add_f32 v[196:197], v[196:197], v[128:129]
    v_pk_add_f32 v[198:199], v[198:199], v[130:131]
    v_cvt_pk_bf16_f32 v196, v196, v197
    v_cvt_pk_bf16_f32 v197, v198, v199
    ds_write_b64 v4, v[196:197] offset:10272
    v_pk_add_f32 v[200:201], v[200:201], v[132:133]
    v_pk_add_f32 v[202:203], v[202:203], v[134:135]
    v_cvt_pk_bf16_f32 v200, v200, v201
    v_cvt_pk_bf16_f32 v201, v202, v203
    ds_write_b64 v4, v[200:201] offset:10304
    s_branch L_rd_264
L_rx_263:
    ds_read_b128 v[112:115], v24 offset:3072
    ds_read_b128 v[116:119], v24 offset:4096
    ds_read_b128 v[124:127], v24 offset:8192
    ds_read_b128 v[128:131], v24 offset:9216
    s_waitcnt lgkmcnt(0)
    v_pk_add_f32 v[184:185], v[184:185], v[112:113]
    v_pk_add_f32 v[186:187], v[186:187], v[114:115]
    v_cvt_pk_bf16_f32 v184, v184, v185
    v_cvt_pk_bf16_f32 v185, v186, v187
    ds_write_b64 v4, v[184:185] offset:96
    v_pk_add_f32 v[188:189], v[188:189], v[116:117]
    v_pk_add_f32 v[190:191], v[190:191], v[118:119]
    v_cvt_pk_bf16_f32 v188, v188, v189
    v_cvt_pk_bf16_f32 v189, v190, v191
    ds_write_b64 v4, v[188:189] offset:128
    v_pk_add_f32 v[204:205], v[204:205], v[124:125]
    v_pk_add_f32 v[206:207], v[206:207], v[126:127]
    v_cvt_pk_bf16_f32 v204, v204, v205
    v_cvt_pk_bf16_f32 v205, v206, v207
    ds_write_b64 v4, v[204:205] offset:10336
    v_pk_add_f32 v[208:209], v[208:209], v[128:129]
    v_pk_add_f32 v[210:211], v[210:211], v[130:131]
    v_cvt_pk_bf16_f32 v208, v208, v209
    v_cvt_pk_bf16_f32 v209, v210, v211
    ds_write_b64 v4, v[208:209] offset:10368
L_rd_264:
    s_cmp_eq_u32 s51, 0
    s_cbranch_scc1 L_rf_265
    s_add_u32 s23, s51, 70
    s_sub_u32 s23, s23, 64
    s_mul_i32 s61, s23, 40960
    s_mul_i32 s23, s23, 5120
    s_add_u32 m0, s23, 0
    s_nop 0
    buffer_load_dwordx4 v10, s[40:43], s61 offen  lds
    s_add_u32 m0, s23, 1024
    s_nop 0
    buffer_load_dwordx4 v11, s[40:43], s61 offen  lds
    s_add_u32 m0, s23, 2048
    s_nop 0
    buffer_load_dwordx4 v12, s[40:43], s61 offen  lds
    s_add_u32 m0, s23, 3072
    s_nop 0
    buffer_load_dwordx4 v13, s[40:43], s61 offen  lds
    s_add_u32 m0, s23, 4096
    s_nop 0
    buffer_load_dwordx4 v14, s[40:43], s61 offen  lds
L_rf_265:
    s_mul_i32 s54, s60, 2560
    s_add_u32 s54, s54, 1280
    s_waitcnt lgkmcnt(0)
    s_barrier
    ds_read_b128 v[32:35], v212 offset:0
L_fr_266:
    ds_read_b128 v[36:39], v213 offset:0
L_fr_267:
    s_cmp_ge_u32 s51, 4
    s_cbranch_scc1 L_fr_268
    ds_read_b128 v[40:43], v214 offset:0
L_fr_268:
    s_cmp_eq_u32 s51, 0
    s_cbranch_scc1 L_rf_269
    s_add_u32 s23, s51, 77
    s_sub_u32 s23, s23, 64
    s_cmp_ge_u32 s23, 20
    s_cbranch_scc1 L_rf_269
    s_mul_i32 s61, s23, 40960
    s_mul_i32 s23, s23, 5120
    s_add_u32 m0, s23, 0
    s_nop 0
    buffer_load_dwordx4 v10, s[40:43], s61 offen  lds
    s_add_u32 m0, s23, 1024
    s_nop 0
    buffer_load_dwordx4 v11, s[40:43], s61 offen  lds
    s_add_u32 m0, s23, 2048
    s_nop 0
    buffer_load_dwordx4 v12, s[40:43], s61 offen  lds
    s_add_u32 m0, s23, 3072
    s_nop 0
    buffer_load_dwordx4 v13, s[40:43], s61 offen  lds
    s_add_u32 m0, s23, 4096
    s_nop 0
    buffer_load_dwordx4 v14, s[40:43], s61 offen  lds
L_rf_269:
    s_waitcnt lgkmcnt(0)
    buffer_store_dwordx4 v[32:35], v216, s[36:39], s54 offen nt
L_fs_270:
    buffer_store_dwordx4 v[36:39], v217, s[36:39], s54 offen nt
L_fs_271:
    s_cmp_ge_u32 s51, 4
    s_cbranch_scc1 L_fs_272
    buffer_store_dwordx4 v[40:43], v218, s[36:39], s54 offen nt
L_fs_272:
    v_lshrrev_b32 v7, 3, v1
    v_and_b32 v8, 7, v1
    v_lshlrev_b32 v7, 7, v7
    v_lshl_add_u32 v7, v8, 2, v7
    s_lshl_b32 s54, s49, 1
    s_add_u32 s54, s54, 1
    s_lshl_b32 s54, s54, 10
    s_add_u32 s54, s54, 16814080
    s_cmp_eq_u32 s51, 0
    s_cbranch_scc0 L_ow_273
    s_mov_b32 exec_lo, -1
    s_mov_b32 exec_hi, -1
    s_mov_b32 s59, 0
L_pp_274:
    buffer_load_dword v6, v7, s[32:35], s54 offen sc1
    s_waitcnt vmcnt(0)
    v_cmp_ne_u32_e64 s[62:63], s3, v6
    s_add_u32 s59, s59, 1
    s_nop 1
    s_cmp_eq_u64 s[62:63], 0
    s_cbranch_scc1 L_pd_275
    s_sleep 1
    s_cmp_lt_u32 s59, 40000
    s_cbranch_scc1 L_pp_274
L_pd_275:
    s_mov_b64 exec, -1
L_ow_273:
    s_waitcnt vmcnt(0)
    s_barrier
    s_lshl_b32 s60, s49, 7
    s_add_u32 s60, s60, 64
    s_lshr_b32 s54, s60, 4
    s_add_u32 s54, s54, s52
    s_add_u32 s54, s54, 0
    s_mul_i32 s54, s54, 20480
    s_add_u32 s54, s54, 10485760
    s_lshl_b32 s55, s53, 13
    s_add_u32 s55, s55, s54
    s_add_u32 s61, s55, 0
    buffer_load_dwordx4 v[32:35], v22, s[32:35], s61 offen sc1
    s_add_u32 s61, s55, 1024
    buffer_load_dwordx4 v[36:39], v22, s[32:35], s61 offen sc1
    s_add_u32 s61, s55, 2048
    buffer_load_dwordx4 v[40:43], v22, s[32:35], s61 offen sc1
    s_add_u32 s61, s55, 3072
    buffer_load_dwordx4 v[44:47], v22, s[32:35], s61 offen sc1
    s_add_u32 s61, s55, 4096
    buffer_load_dwordx4 v[48:51], v22, s[32:35], s61 offen sc1
    s_add_u32 s61, s55, 5120
    buffer_load_dwordx4 v[52:55], v22, s[32:35], s61 offen sc1
    s_add_u32 s61, s55, 6144
    buffer_load_dwordx4 v[56:59], v22, s[32:35], s61 offen sc1
    s_add_u32 s61, s55, 7168
    buffer_load_dwordx4 v[60:63], v22, s[32:35], s61 offen sc1
    s_lshl_b32 s55, s53, 11
    s_add_u32 s55, s55, s54
    s_add_u32 s61, s55, 16384
    buffer_load_dwordx4 v[64:67], v22, s[32:35], s61 offen sc1
    s_add_u32 s61, s55, 17408
    buffer_load_dwordx4 v[68:71], v22, s[32:35], s61 offen sc1
    ds_read_b64_tr_b16 v[112:113], v20 offset:0
    ds_read_b64_tr_b16 v[114:115], v20 offset:1280
    ds_read_b64_tr_b16 v[116:117], v20 offset:32
    ds_read_b64_tr_b16 v[118:119], v20 offset:1312
    ds_read_b64_tr_b16 v[120:121], v20 offset:64
    ds_read_b64_tr_b16 v[122:123], v20 offset:1344
    ds_read_b64_tr_b16 v[124:125], v20 offset:96
    ds_read_b64_tr_b16 v[126:127], v20 offset:1376
    ds_read_b64_tr_b16 v[128:129], v20 offset:128
    ds_read_b64_tr_b16 v[130:131], v20 offset:1408
    ds_read_b64_tr_b16 v[132:133], v20 offset:6400
    ds_read_b64_tr_b16 v[134:135], v20 offset:7680
    ds_read_b64_tr_b16 v[136:137], v20 offset:6432
    ds_read_b64_tr_b16 v[138:139], v20 offset:7712
    ds_read_b64_tr_b16 v[140:141], v20 offset:6464
    ds_read_b64_tr_b16 v[142:143], v20 offset:7744
    ds_read_b64_tr_b16 v[144:145], v20 offset:6496
    ds_read_b64_tr_b16 v[146:147], v20 offset:7776
    ds_read_b64_tr_b16 v[148:149], v20 offset:6528
    ds_read_b64_tr_b16 v[150:151], v20 offset:7808
    s_waitcnt vmcnt(9)
    s_waitcnt lgkmcnt(15)
    v_mfma_f32_16x16x32_bf16 v[172:175], v[112:115], v[32:35], 0
    ds_read_b64_tr_b16 v[152:153], v20 offset:12800
    ds_read_b64_tr_b16 v[154:155], v20 offset:14080
    v_mfma_f32_16x16x32_bf16 v[176:179], v[116:119], v[32:35], 0
    ds_read_b64_tr_b16 v[156:157], v20 offset:12832
    ds_read_b64_tr_b16 v[158:159], v20 offset:14112
    s_waitcnt lgkmcnt(15)
    v_mfma_f32_16x16x32_bf16 v[180:183], v[120:123], v[32:35], 0
    ds_read_b64_tr_b16 v[160:161], v20 offset:12864
    ds_read_b64_tr_b16 v[162:163], v20 offset:14144
    v_mfma_f32_16x16x32_bf16 v[184:187], v[124:127], v[32:35], 0
    ds_read_b64_tr_b16 v[164:165], v20 offset:12896
    ds_read_b64_tr_b16 v[166:167], v20 offset:14176
    s_waitcnt lgkmcnt(15)
    v_mfma_f32_16x16x32_bf16 v[188:191], v[128:131], v[32:35], 0
    ds_read_b64_tr_b16 v[168:169], v20 offset:12928
    ds_read_b64_tr_b16 v[170:171], v20 offset:14208
    s_waitcnt vmcnt(8)
    v_mfma_f32_16x16x32_bf16 v[172:175], v[132:135], v[36:39], v[172:175]
    ds_read_b64_tr_b16 v[112:113], v20 offset:19200
    ds_read_b64_tr_b16 v[114:115], v20 offset:20480
    s_waitcnt lgkmcnt(15)
    v_mfma_f32_16x16x32_bf16 v[176:179], v[136:139], v[36:39], v[176:179]
    ds_read_b64_tr_b16 v[116:117], v20 offset:19232
    ds_read_b64_tr_b16 v[118:119], v20 offset:20512
    v_mfma_f32_16x16x32_bf16 v[180:183], v[140:143], v[36:39], v[180:183]
    ds_read_b64_tr_b16 v[120:121], v20 offset:19264
    ds_read_b64_tr_b16 v[122:123], v20 offset:20544
    s_waitcnt lgkmcnt(15)
    v_mfma_f32_16x16x32_bf16 v[184:187], v[144:147], v[36:39], v[184:187]
    ds_read_b64_tr_b16 v[124:125], v20 offset:19296
    ds_read_b64_tr_b16 v[126:127], v20 offset:20576
    v_mfma_f32_16x16x32_bf16 v[188:191], v[148:151], v[36:39], v[188:191]
    ds_read_b64_tr_b16 v[128:129], v20 offset:19328
    ds_read_b64_tr_b16 v[130:131], v20 offset:20608
    s_waitcnt vmcnt(7)
    s_waitcnt lgkmcnt(15)
    v_mfma_f32_16x16x32_bf16 v[172:175], v[152:155], v[40:43], v[172:175]
    ds_read_b64_tr_b16 v[132:133], v20 offset:25600
    ds_read_b64_tr_b16 v[134:135], v20 offset:26880
    v_mfma_f32_16x16x32_bf16 v[176:179], v[156:159], v[40:43], v[176:179]
    ds_read_b64_tr_b16 v[136:137], v20 offset:25632
    ds_read_b64_tr_b16 v[138:139], v20 offset:26912
    s_waitcnt lgkmcnt(15)
    v_mfma_f32_16x16x32_bf16 v[180:183], v[160:163], v[40:43], v[180:183]
    ds_read_b64_tr_b16 v[140:141], v20 offset:25664
    ds_read_b64_tr_b16 v[142:143], v20 offset:26944
    v_mfma_f32_16x16x32_bf16 v[184:187], v[164:167], v[40:43], v[184:187]
    ds_read_b64_tr_b16 v[144:145], v20 offset:25696
    ds_read_b64_tr_b16 v[146:147], v20 offset:26976
    s_waitcnt lgkmcnt(15)
    v_mfma_f32_16x16x32_bf16 v[188:191], v[168:171], v[40:43], v[188:191]
    ds_read_b64_tr_b16 v[148:149], v20 offset:25728
    ds_read_b64_tr_b16 v[150:151], v20 offset:27008
    s_waitcnt vmcnt(6)
    v_mfma_f32_16x16x32_bf16 v[172:175], v[112:115], v[44:47], v[172:175]
    ds_read_b64_tr_b16 v[152:153], v20 offset:32000
    ds_read_b64_tr_b16 v[154:155], v20 offset:33280
    s_waitcnt lgkmcnt(15)
    v_mfma_f32_16x16x32_bf16 v[176:179], v[116:119], v[44:47], v[176:179]
    ds_read_b64_tr_b16 v[156:157], v20 offset:32032
    ds_read_b64_tr_b16 v[158:159], v20 offset:33312
    v_mfma_f32_16x16x32_bf16 v[180:183], v[120:123], v[44:47], v[180:183]
    ds_read_b64_tr_b16 v[160:161], v20 offset:32064
    ds_read_b64_tr_b16 v[162:163], v20 offset:33344
    s_waitcnt lgkmcnt(15)
    v_mfma_f32_16x16x32_bf16 v[184:187], v[124:127], v[44:47], v[184:187]
    ds_read_b64_tr_b16 v[164:165], v20 offset:32096
    ds_read_b64_tr_b16 v[166:167], v20 offset:33376
    v_mfma_f32_16x16x32_bf16 v[188:191], v[128:131], v[44:47], v[188:191]
    ds_read_b64_tr_b16 v[168:169], v20 offset:32128
    ds_read_b64_tr_b16 v[170:171], v20 offset:33408
    s_waitcnt vmcnt(5)
    s_waitcnt lgkmcnt(15)
    v_mfma_f32_16x16x32_bf16 v[172:175], v[132:135], v[48:51], v[172:175]
    ds_read_b64_tr_b16 v[112:113], v20 offset:38400
    ds_read_b64_tr_b16 v[114:115], v20 offset:39680
    v_mfma_f32_16x16x32_bf16 v[176:179], v[136:139], v[48:51], v[176:179]
    ds_read_b64_tr_b16 v[116:117], v20 offset:38432
    ds_read_b64_tr_b16 v[118:119], v20 offset:39712
    s_waitcnt lgkmcnt(15)
    v_mfma_f32_16x16x32_bf16 v[180:183], v[140:143], v[48:51], v[180:183]
    ds_read_b64_tr_b16 v[120:121], v20 offset:38464
    ds_read_b64_tr_b16 v[122:123], v20 offset:39744
    v_mfma_f32_16x16x32_bf16 v[184:187], v[144:147], v[48:51], v[184:187]
    ds_read_b64_tr_b16 v[124:125], v20 offset:38496
    ds_read_b64_tr_b16 v[126:127], v20 offset:39776
    s_waitcnt lgkmcnt(15)
    v_mfma_f32_16x16x32_bf16 v[188:191], v[148:151], v[48:51], v[188:191]
    ds_read_b64_tr_b16 v[128:129], v20 offset:38528
    ds_read_b64_tr_b16 v[130:131], v20 offset:39808
    s_waitcnt vmcnt(4)
    v_mfma_f32_16x16x32_bf16 v[172:175], v[152:155], v[52:55], v[172:175]
    ds_read_b64_tr_b16 v[132:133], v20 offset:44800
    ds_read_b64_tr_b16 v[134:135], v20 offset:46080
    s_waitcnt lgkmcnt(15)
    v_mfma_f32_16x16x32_bf16 v[176:179], v[156:159], v[52:55], v[176:179]
    ds_read_b64_tr_b16 v[136:137], v20 offset:44832
    ds_read_b64_tr_b16 v[138:139], v20 offset:46112
    v_mfma_f32_16x16x32_bf16 v[180:183], v[160:163], v[52:55], v[180:183]
    ds_read_b64_tr_b16 v[140:141], v20 offset:44864
    ds_read_b64_tr_b16 v[142:143], v20 offset:46144
    s_waitcnt lgkmcnt(15)
    v_mfma_f32_16x16x32_bf16 v[184:187], v[164:167], v[52:55], v[184:187]
    ds_read_b64_tr_b16 v[144:145], v20 offset:44896
    ds_read_b64_tr_b16 v[146:147], v20 offset:46176
    v_mfma_f32_16x16x32_bf16 v[188:191], v[168:171], v[52:55], v[188:191]
    ds_read_b64_tr_b16 v[148:149], v20 offset:44928
    ds_read_b64_tr_b16 v[150:151], v20 offset:46208
    s_waitcnt vmcnt(3)
    s_waitcnt lgkmcnt(15)
    v_mfma_f32_16x16x32_bf16 v[172:175], v[112:115], v[56:59], v[172:175]
    ds_read_b64_tr_b16 v[152:153], v21 offset:0
    ds_read_b64_tr_b16 v[154:155], v21 offset:3200
    v_mfma_f32_16x16x32_bf16 v[176:179], v[116:119], v[56:59], v[176:179]
    ds_read_b64_tr_b16 v[156:157], v21 offset:32
    ds_read_b64_tr_b16 v[158:159], v21 offset:3232
    s_waitcnt lgkmcnt(15)
    v_mfma_f32_16x16x32_bf16 v[180:183], v[120:123], v[56:59], v[180:183]
    ds_read_b64_tr_b16 v[160:161], v21 offset:64
    ds_read_b64_tr_b16 v[162:163], v21 offset:3264
    v_mfma_f32_16x16x32_bf16 v[184:187], v[124:127], v[56:59], v[184:187]
    ds_read_b64_tr_b16 v[164:165], v21 offset:96
    ds_read_b64_tr_b16 v[166:167], v21 offset:3296
    s_waitcnt lgkmcnt(15)
    v_mfma_f32_16x16x32_bf16 v[188:191], v[128:131], v[56:59], v[188:191]
    ds_read_b64_tr_b16 v[168:169], v21 offset:128
    ds_read_b64_tr_b16 v[170:171], v21 offset:3328
    s_waitcnt vmcnt(2)
    v_mfma_f32_16x16x32_bf16 v[172:175], v[132:135], v[60:63], v[172:175]
    ds_read_b64_tr_b16 v[112:113], v21 offset:25600
    ds_read_b64_tr_b16 v[114:115], v21 offset:28800
    s_waitcnt lgkmcnt(15)
    v_mfma_f32_16x16x32_bf16 v[176:179], v[136:139], v[60:63], v[176:179]
    ds_read_b64_tr_b16 v[116:117], v21 offset:25632
    ds_read_b64_tr_b16 v[118:119], v21 offset:28832
    v_mfma_f32_16x16x32_bf16 v[180:183], v[140:143], v[60:63], v[180:183]
    ds_read_b64_tr_b16 v[120:121], v21 offset:25664
    ds_read_b64_tr_b16 v[122:123], v21 offset:28864
    s_waitcnt lgkmcnt(15)
    v_mfma_f32_16x16x32_bf16 v[184:187], v[144:147], v[60:63], v[184:187]
    ds_read_b64_tr_b16 v[124:125], v21 offset:25696
    ds_read_b64_tr_b16 v[126:127], v21 offset:28896
    v_mfma_f32_16x16x32_bf16 v[188:191], v[148:151], v[60:63], v[188:191]
    ds_read_b64_tr_b16 v[128:129], v21 offset:25728
    ds_read_b64_tr_b16 v[130:131], v21 offset:28928
    s_waitcnt vmcnt(1)
    s_waitcnt lgkmcnt(15)
    v_mfma_f32_16x16x32_bf16 v[172:175], v[152:155], v[64:67], v[172:175]
    v_mfma_f32_16x16x32_bf16 v[176:179], v[156:159], v[64:67], v[176:179]
    s_waitcnt lgkmcnt(14)
    v_mfma_f32_16x16x32_bf16 v[180:183], v[160:163], v[64:67], v[180:183]
    s_waitcnt lgkmcnt(12)
    v_mfma_f32_16x16x32_bf16 v[184:187], v[164:167], v[64:67], v[184:187]
    s_waitcnt lgkmcnt(10)
    v_mfma_f32_16x16x32_bf16 v[188:191], v[168:171], v[64:67], v[188:191]
    s_waitcnt vmcnt(0)
    s_waitcnt lgkmcnt(8)
    v_mfma_f32_16x16x32_bf16 v[172:175], v[112:115], v[68:71], v[172:175]
    s_waitcnt lgkmcnt(6)
    v_mfma_f32_16x16x32_bf16 v[176:179], v[116:119], v[68:71], v[176:179]
    s_waitcnt lgkmcnt(4)
    v_mfma_f32_16x16x32_bf16 v[180:183], v[120:123], v[68:71], v[180:183]
    s_waitcnt lgkmcnt(2)
    v_mfma_f32_16x16x32_bf16 v[184:187], v[124:127], v[68:71], v[184:187]
    s_waitcnt lgkmcnt(0)
    v_mfma_f32_16x16x32_bf16 v[188:191], v[128:131], v[68:71], v[188:191]
    s_lshl_b32 s54, s52, 4
    v_add_u32 v4, s54, v2
    s_movk_i32 s55, 160
    v_mul_u32_u24 v4, s55, v4
    v_lshl_add_u32 v4, v3, 3, v4
    v_add_u32 v4, 143360, v4
    s_nop 2
    s_cmp_eq_u32 s53, 0
    s_cbranch_scc0 L_rx_276
    ds_write_b128 v24, v[184:187] offset:3072
    ds_write_b128 v24, v[188:191] offset:4096
    s_branch L_rd_277
L_rx_276:
    ds_write_b128 v24, v[172:175] offset:0
    ds_write_b128 v24, v[176:179] offset:1024
    ds_write_b128 v24, v[180:183] offset:2048
L_rd_277:
    s_lshl_b32 s54, s51, 6
    v_add_u32 v5, s54, v1
    s_movk_i32 s56, 6554
    s_movk_i32 s57, 2560
    s_mul_i32 s58, s50, 160
    v_add_u32 v6, 0, v5
    v_mul_u32_u24 v7, s56, v6
    v_lshrrev_b32 v7, 16, v7
    v_mul_u32_u24 v8, 10, v7
    v_sub_u32 v8, v6, v8
    v_mul_u32_u24 v9, s55, v7
    v_lshl_add_u32 v9, v8, 4, v9
    v_add_u32 v212, 143360, v9
    v_mul_u32_u24 v9, s57, v7
    v_lshl_add_u32 v9, v8, 4, v9
    v_add_u32 v216, s58, v9
    v_add_u32 v6, 512, v5
    v_mul_u32_u24 v7, s56, v6
    v_lshrrev_b32 v7, 16, v7
    v_mul_u32_u24 v8, 10, v7
    v_sub_u32 v8, v6, v8
    v_mul_u32_u24 v9, s55, v7
    v_lshl_add_u32 v9, v8, 4, v9
    v_add_u32 v213, 143360, v9
    v_mul_u32_u24 v9, s57, v7
    v_lshl_add_u32 v9, v8, 4, v9
    v_add_u32 v217, s58, v9
    s_waitcnt lgkmcnt(0)
    s_barrier
    s_cmp_eq_u32 s53, 0
    s_cbranch_scc0 L_rx_278
    ds_read_b128 v[112:115], v24 offset:0
    ds_read_b128 v[116:119], v24 offset:1024
    ds_read_b128 v[120:123], v24 offset:2048
    s_waitcnt lgkmcnt(0)
    v_pk_add_f32 v[172:173], v[172:173], v[112:113]
    v_pk_add_f32 v[174:175], v[174:175], v[114:115]
    v_cvt_pk_bf16_f32 v172, v172, v173
    v_cvt_pk_bf16_f32 v173, v174, v175
    ds_write_b64 v4, v[172:173] offset:0
    v_pk_add_f32 v[176:177], v[176:177], v[116:117]
    v_pk_add_f32 v[178:179], v[178:179], v[118:119]
    v_cvt_pk_bf16_f32 v176, v176, v177
    v_cvt_pk_bf16_f32 v177, v178, v179
    ds_write_b64 v4, v[176:177] offset:32
    v_pk_add_f32 v[180:181], v[180:181], v[120:121]
    v_pk_add_f32 v[182:183], v[182:183], v[122:123]
    v_cvt_pk_bf16_f32 v180, v180, v181
    v_cvt_pk_bf16_f32 v181, v182, v183
    ds_write_b64 v4, v[180:181] offset:64
    s_branch L_rd_279
L_rx_278:
    ds_read_b128 v[112:115], v24 offset:3072
    ds_read_b128 v[116:119], v24 offset:4096
    s_waitcnt lgkmcnt(0)
    v_pk_add_f32 v[184:185], v[184:185], v[112:113]
    v_pk_add_f32 v[186:187], v[186:187], v[114:115]
    v_cvt_pk_bf16_f32 v184, v184, v185
    v_cvt_pk_bf16_f32 v185, v186, v187
    ds_write_b64 v4, v[184:185] offset:96
    v_pk_add_f32 v[188:189], v[188:189], v[116:117]
    v_pk_add_f32 v[190:191], v[190:191], v[118:119]
    v_cvt_pk_bf16_f32 v188, v188, v189
    v_cvt_pk_bf16_f32 v189, v190, v191
    ds_write_b64 v4, v[188:189] offset:128
L_rd_279:
    s_mul_i32 s54, s60, 2560
    s_add_u32 s54, s54, 0
    s_waitcnt lgkmcnt(0)
    s_barrier
    ds_read_b128 v[32:35], v212 offset:0
L_fr_280:
    s_cmp_ge_u32 s51, 2
    s_cbranch_scc1 L_fr_281
    ds_read_b128 v[36:39], v213 offset:0
L_fr_281:
    s_waitcnt lgkmcnt(0)
    buffer_store_dwordx4 v[32:35], v216, s[36:39], s54 offen nt
L_fs_282:
    s_cmp_ge_u32 s51, 2
    s_cbranch_scc1 L_fs_283
    buffer_store_dwordx4 v[36:39], v217, s[36:39], s54 offen nt
L_fs_283:
L_fin:
    s_cmp_eq_u32 s2, 0
    s_cbranch_scc0 L_ep_284
    v_lshlrev_b32 v7, 7, v1
    s_mov_b32 s54, 16781312
    s_cmp_eq_u32 s51, 0
    s_cbranch_scc0 L_ow_285
    s_mov_b32 exec_lo, -1
    s_mov_b32 exec_hi, -1
    s_mov_b32 s59, 0
L_pp_286:
    buffer_load_dword v6, v7, s[32:35], s54 offen sc1
    s_waitcnt vmcnt(0)
    v_cmp_ne_u32_e64 s[62:63], s3, v6
    s_add_u32 s59, s59, 1
    s_nop 1
    s_cmp_eq_u64 s[62:63], 0
    s_cbranch_scc1 L_pd_287
    s_sleep 1
    s_cmp_lt_u32 s59, 40000
    s_cbranch_scc1 L_pp_286
L_pd_287:
    s_mov_b64 exec, -1
L_ow_285:
    s_mov_b32 s54, 16789504
    s_cmp_eq_u32 s51, 0
    s_cbranch_scc0 L_ow_288
    s_mov_b32 exec_lo, -1
    s_mov_b32 exec_hi, -1
    s_mov_b32 s59, 0
L_pp_289:
    buffer_load_dword v6, v7, s[32:35], s54 offen sc1
    s_waitcnt vmcnt(0)
    v_cmp_ne_u32_e64 s[62:63], s3, v6
    s_add_u32 s59, s59, 1
    s_nop 1
    s_cmp_eq_u64 s[62:63], 0
    s_cbranch_scc1 L_pd_290
    s_sleep 1
    s_cmp_lt_u32 s59, 40000
    s_cbranch_scc1 L_pp_289
L_pd_290:
    s_mov_b64 exec, -1
L_ow_288:
    s_mov_b32 s54, 16797696
    s_cmp_eq_u32 s51, 0
    s_cbranch_scc0 L_ow_291
    s_mov_b32 exec_lo, -1
    s_mov_b32 exec_hi, -1
    s_mov_b32 s59, 0
L_pp_292:
    buffer_load_dword v6, v7, s[32:35], s54 offen sc1
    s_waitcnt vmcnt(0)
    v_cmp_ne_u32_e64 s[62:63], s3, v6
    s_add_u32 s59, s59, 1
    s_nop 1
    s_cmp_eq_u64 s[62:63], 0
    s_cbranch_scc1 L_pd_293
    s_sleep 1
    s_cmp_lt_u32 s59, 40000
    s_cbranch_scc1 L_pp_292
L_pd_293:
    s_mov_b64 exec, -1
L_ow_291:
    s_mov_b32 s54, 16805888
    s_cmp_eq_u32 s51, 0
    s_cbranch_scc0 L_ow_294
    s_mov_b32 exec_lo, -1
    s_mov_b32 exec_hi, -1
    s_mov_b32 s59, 0
L_pp_295:
    buffer_load_dword v6, v7, s[32:35], s54 offen sc1
    s_waitcnt vmcnt(0)
    v_cmp_ne_u32_e64 s[62:63], s3, v6
    s_add_u32 s59, s59, 1
    s_nop 1
    s_cmp_eq_u64 s[62:63], 0
    s_cbranch_scc1 L_pd_296
    s_sleep 1
    s_cmp_lt_u32 s59, 40000
    s_cbranch_scc1 L_pp_295
L_pd_296:
    s_mov_b64 exec, -1
L_ow_294:
    s_mov_b32 s54, 16777216
    s_cmp_eq_u32 s51, 0
    s_cbranch_scc0 L_ow_297
    v_mov_b32 v4, s3
    v_mov_b32 v5, 0
    s_mov_b64 exec, 1
    buffer_store_dword v4, v5, s[32:35], s54 offen sc0 sc1
    s_mov_b64 exec, -1
L_ow_297:
L_ep_284:
L_fin2:
L_end:
    s_endpgm
L_codeend:
.set CODE_TOTAL, L_codeend - L_pcbase
.set CODE_CHUNK, ((CODE_TOTAL / 8 + 127) / 128) * 128
.set CODE_LAST, CODE_TOTAL - 4
.section .rodata,"a"
.p2align 6
.amdhsa_kernel concat_heads__sliding_block__linear_attn_block__prompt_kernel
  .amdhsa_next_free_vgpr 256
  .amdhsa_next_free_sgpr 102
  .amdhsa_accum_offset 256
  .amdhsa_group_segment_fixed_size 0
  .amdhsa_kernarg_size 72
  .amdhsa_user_sgpr_count 2
  .amdhsa_user_sgpr_kernarg_segment_ptr 1
  .amdhsa_system_sgpr_workgroup_id_x 1
.end_amdhsa_kernel
```
